```python
import torch

def _softmax(x, axis=-1):
    return torch.softmax(x, dim=axis)
def _gelu(x):
    return torch.nn.functional.gelu(x, approximate="tanh")
def _silu(x):
    return torch.nn.functional.silu(x)
def _sigmoid(x):
    return torch.sigmoid(x)
def _layernorm(x, axis=-1, eps=1e-5):
    m = x.mean(dim=axis, keepdim=True)
    v = x.var(dim=axis, keepdim=True, unbiased=False)
    return (x - m) / torch.sqrt(v + eps)
def _scatter_add(tgt, idx, src, axis=0):
    return tgt.clone().index_add_(axis, idx, src)
def _segment_sum(src, seg, n):
    out = torch.zeros((n,) + src.shape[1:], dtype=src.dtype)
    return out.index_add_(0, seg, src)
def _pad(x, pw):
    flat = tuple(v for pair in reversed(pw) for v in pair)
    return torch.nn.functional.pad(x, flat)

kernel_name = 'standalone__seq2seq_rnn_t_joint__speech'

def setup_inputs():

    _w = (lambda a: (lambda t: t.to(torch.bfloat16) if t.is_floating_point() else t)(torch.as_tensor(a)))
    B, T, D, K = 2, 4000, 512, 3
    U = 8
    sc = (1.0 / (K * D)) ** 0.5
    sd = (1.0 / D) ** 0.5
    return {
        "x": _w((lambda *s: torch.randn(*s, dtype=torch.bfloat16) * 0.2)(B, T, D) * 0.5),
        "w1": _w((lambda *s: torch.randn(*s, dtype=torch.bfloat16) * 3.2)(K, D, D) * sc),
        "w2": _w((lambda *s: torch.randn(*s, dtype=torch.bfloat16) * 3.2)(K, D, D) * sc),
        "g": _w((lambda *s: torch.randn(*s, dtype=torch.bfloat16) * 3.2)(B, U, D) * 0.5),
        "w_f": _w((lambda *s: torch.randn(*s, dtype=torch.bfloat16) * 3.2)(D, D) * sd),
        "w_g": _w((lambda *s: torch.randn(*s, dtype=torch.bfloat16) * 3.2)(D, D) * sd),
        "w_o": _w((lambda *s: torch.randn(*s, dtype=torch.bfloat16) * 3.2)(D, D) * sd),
    }

def reference(x, w1, w2, g, w_f, w_g, w_o):
    B, T, D = x.shape
    K = w1.shape[0]
    pad = K // 2
    xp = _pad(x, ((0,0),(pad,pad),(0,0)))
    h = torch.zeros_like(x)
    for i in range(K):
        h = h + torch.einsum("btc,cd->btd", xp[:, i:i+T, :], w1[i])
    h = _gelu(h)[:, ::2, :]
    T1 = h.shape[1]
    hp = _pad(h, ((0,0),(pad,pad),(0,0)))
    f = torch.zeros_like(h)
    for i in range(K):
        f = f + torch.einsum("btc,cd->btd", hp[:, i:i+T1, :], w2[i])
    f = _gelu(f)[:, ::2, :]
    fe = torch.einsum("btd,de->bte", f, w_f)
    ge = torch.einsum("bud,de->bue", g, w_g)
    j = torch.tanh(fe[:, :, None, :] + ge[:, None, :, :])
    return torch.einsum("btud,dv->btuv", j, w_o)
```

```asm
; @launch grid=(256,1,1) block=(256,1,1) lds=163840
.amdgcn_target "amdgcn-amd-amdhsa--gfx950"
.text
.globl standalone__seq2seq_rnn_t_joint__speech_kernel
.p2align 12
.p2align 8
.type standalone__seq2seq_rnn_t_joint__speech_kernel,@function
standalone__seq2seq_rnn_t_joint__speech_kernel:
    s_cmp_ge_u32 s2, 256
    s_cbranch_scc1 L_END
    s_load_dwordx16 s[16:31], s[0:1], 0
    s_load_dwordx4 s[32:35], s[0:1], 64
    v_cmp_gt_u32 vcc, 8, v0
    s_getpc_b64 s[12:13]
    s_and_b32 s12, s12, 0xfffff000
    s_lshr_b32 s82, s2, 3
    s_mul_i32 s82, s82, 8
    v_add_lshl_u32 v5, s82, v0, 7
    s_and_saveexec_b64 s[56:57], vcc
    s_cbranch_execz L_ncp_1
    global_load_dword v208, v5, s[12:13]
L_ncp_1:
    s_mov_b64 exec, -1
    v_lshrrev_b32 v5, 6, v0
    v_and_b32 v1, 63, v0
    v_readfirstlane_b32 s72, v5
    s_and_b32 s82, s2, 7
    s_lshr_b32 s83, s2, 6
    s_lshl_b32 s73, s82, 2
    s_add_u32 s73, s73, s83
    s_lshr_b32 s74, s2, 3
    s_and_b32 s74, s74, 7
    s_lshr_b32 s75, s73, 4
    s_and_b32 s76, s73, 15
    v_lshlrev_b32 v2, 4, v1
    v_and_b32 v3, 15, v1
    v_lshrrev_b32 v4, 4, v1
    s_add_u32 s14, s83, s74
    s_and_b32 s14, s14, 1
    s_mul_i32 s14, s14, 1
    s_mov_b32 s15, s82
    s_add_u32 s79, s14, s15
    s_and_b32 s79, s79, 7
    s_lshl_b32 s77, s79, 7
    s_lshl_b32 s78, s79, 16
    v_lshrrev_b32 v5, 3, v1
    v_and_b32 v6, 7, v1
    v_lshrrev_b32 v7, 1, v5
    v_xor_b32 v8, v6, v7
    v_lshlrev_b32 v8, 4, v8
    v_lshl_add_u32 v8, v5, 14, v8
    s_mul_i32 s84, s76, 252
    s_lshl_b32 s85, s72, 2
    s_add_u32 s84, s84, s85
    s_sub_u32 s84, s84, 3
    s_lshl_b32 s84, s84, 10
    v_add_u32 v12, s84, v8
    v_xor_b32 v8, 64, v12
    s_lshl_b32 s80, s72, 13
    v_add_u32 v13, 130048, v8
    v_add_u32 v14, 1024, v12
    v_add_u32 v15, 131072, v8
    v_add_u32 v16, 2048, v12
    v_add_u32 v17, 132096, v8
    v_add_u32 v18, 3072, v12
    v_add_u32 v19, 133120, v8
    v_and_b32 v7, 1, v7
    v_lshlrev_b32 v7, 2, v7
    v_xor_b32 v7, v6, v7
    v_lshlrev_b32 v7, 4, v7
    v_lshl_add_u32 v26, v5, 10, v7
    v_xor_b32 v8, 32, v26
    s_lshl_b32 s84, s72, 14
    s_lshl_b32 s87, s74, 7
    s_add_u32 s84, s84, s87
    v_add_u32 v20, s84, v26
    v_add_u32 v8, s84, v8
    s_lshl_b32 s81, s72, 11
    s_add_u32 s81, s81, 98304
    v_add_u32 v21, 7168, v8
    v_add_u32 v22, 524288, v20
    v_add_u32 v23, 531456, v8
    v_add_u32 v24, 1048576, v20
    v_add_u32 v25, 1055744, v8
    s_mul_i32 s82, s75, 4096000
    s_mov_b32 s38, 4096000
    s_mov_b32 s39, 0x20000
    s_mov_b32 s42, 1572864
    s_mov_b32 s43, 0x20000
    s_waitcnt lgkmcnt(0)
    s_add_u32 s36, s16, s82
    s_addc_u32 s37, s17, 0
    s_and_b32 s37, s37, 0xffff
    s_mov_b32 s40, s18
    s_add_u32 m0, s80, 0
    s_and_b32 s41, s19, 0xffff
    buffer_load_dwordx4 v12, s[36:39], s77 offen offset:0  lds
    buffer_load_dwordx4 v13, s[36:39], s77 offen offset:1024  lds
    s_add_u32 m0, s81, 0
    s_nop 0
    buffer_load_dwordx4 v20, s[40:43], s78 offen offset:0  lds
    buffer_load_dwordx4 v21, s[40:43], s78 offen offset:1024  lds
    s_add_u32 m0, s81, 8192
    s_nop 0
    buffer_load_dwordx4 v22, s[40:43], s78 offen offset:0  lds
    buffer_load_dwordx4 v23, s[40:43], s78 offen offset:1024  lds
    s_mov_b32 s44, s34
    s_and_b32 s45, s35, 0xffff
    s_mov_b32 s46, 33554432
    s_mov_b32 s47, 0x20000
    s_lshl_b32 s82, s74, 2
    s_add_u32 s82, s82, s72
    s_cmp_eq_u32 s82, 3
    s_cbranch_scc0 L_nz_2
    s_lshl_b32 s83, s73, 10
    s_add_u32 s83, s83, 14155776
    v_lshlrev_b32 v5, 7, v1
    v_add_u32 v5, s83, v5
    s_lshl_b32 s83, s73, 7
    s_add_u32 s83, s83, 14221184
    v_add_u32 v6, s83, v2
    v_cmp_gt_u32 vcc, 8, v1
    s_nop 1
    v_cndmask_b32 v5, v6, v5, vcc
    v_mov_b32 v32, 0
    v_mov_b32 v33, 0
    v_mov_b32 v34, 0
    v_mov_b32 v35, 0
    s_mov_b64 exec, 0x3ff
    buffer_store_dwordx4 v[32:35], v5, s[44:47], 0 offen sc1
    s_mov_b64 exec, -1
L_nz_2:
    s_add_u32 m0, s80, 2048
    s_nop 0
    buffer_load_dwordx4 v14, s[36:39], s77 offen offset:0  lds
    buffer_load_dwordx4 v15, s[36:39], s77 offen offset:1024  lds
    s_add_u32 m0, s80, 4096
    s_nop 0
    buffer_load_dwordx4 v16, s[36:39], s77 offen offset:0  lds
    buffer_load_dwordx4 v17, s[36:39], s77 offen offset:1024  lds
    s_add_u32 m0, s81, 16384
    s_nop 0
    buffer_load_dwordx4 v24, s[40:43], s78 offen offset:0  lds
    buffer_load_dwordx4 v25, s[40:43], s78 offen offset:1024  lds
    s_add_u32 m0, s80, 6144
    s_nop 0
    buffer_load_dwordx4 v18, s[36:39], s77 offen offset:0  lds
    buffer_load_dwordx4 v19, s[36:39], s77 offen offset:1024  lds
    s_mov_b32 s56, s20
    s_and_b32 s57, s21, 0xffff
    s_mov_b32 s58, 1572864
    s_mov_b32 s59, 0x20000
    s_cmp_lt_u32 s2, 128
    s_cselect_b32 s60, s20, s26
    s_cselect_b32 s61, s21, s27
    s_cselect_b32 s62, 3, 1
    s_cselect_b32 s64, s24, s28
    s_cselect_b32 s65, s25, s29
    s_mov_b32 s66, 524288
    s_cselect_b32 s89, 1048576, 0
    s_cselect_b32 s9, 0, 1
    s_and_b32 s61, s61, 0xffff
    s_and_b32 s65, s65, 0xffff
    s_lshl_b32 s62, s62, 19
    s_mov_b32 s63, 0x20000
    s_mov_b32 s67, 0x20000
    s_lshr_b32 s82, s2, 3
    s_and_b32 s82, s82, 15
    s_and_b32 s83, s2, 7
    s_lshl_b32 s90, s82, 15
    s_lshl_b32 s84, s83, 7
    s_add_u32 s90, s90, s84
    s_add_u32 s90, s90, s80
    s_add_u32 s89, s89, s90
    s_lshl_b32 s84, s9, 19
    s_add_u32 s88, s90, s84
    s_lshl_b32 s84, s72, 10
    s_add_u32 s84, s84, 147456
    s_add_u32 m0, s84, 0
    s_nop 0
    buffer_load_dwordx4 v26, s[56:59], s88 offen  lds
    s_add_u32 m0, s84, 4096
    s_nop 0
    buffer_load_dwordx4 v26, s[60:63], s89 offen  lds
    s_add_u32 m0, s84, 8192
    s_nop 0
    buffer_load_dwordx4 v26, s[64:67], s90 offen  lds
    s_xor_b32 s77, s14, 1
    s_add_u32 s77, s77, s15
    s_and_b32 s77, s77, 7
    s_lshl_b32 s77, s77, 7
    s_xor_b32 s78, s14, 1
    s_add_u32 s78, s78, s15
    s_and_b32 s78, s78, 7
    s_lshl_b32 s78, s78, 16
    s_mov_b64 exec, 0
    s_cmp_eq_u32 s72, 0
    s_cbranch_scc1 L_PAD0
    s_cmp_eq_u32 s72, 1
    s_cbranch_scc1 L_PAD1
    s_cmp_eq_u32 s72, 2
    s_cbranch_scc1 L_PAD2
    s_cmp_eq_u32 s72, 3
    s_cbranch_scc1 L_PAD3
    s_nop 0
    s_nop 0
L_PADRET:
    s_mov_b64 exec, -1
    s_nop 0
    s_mov_b32 s52, s32
    s_and_b32 s53, s33, 0xffff
    s_mov_b32 s54, 256
    s_mov_b32 s55, 0x20000
    s_add_u32 m0, s81, 24576
    s_and_b32 s98, s72, 1
    buffer_load_dwordx4 v20, s[40:43], s78 offen offset:0  lds
    s_lshr_b32 s99, s72, 1
    s_lshl_b32 s87, s83, 2
    s_add_u32 s87, s87, s72
    s_lshl_b32 s87, s87, 4
    s_add_u32 s87, s87, s82
    s_mul_i32 s91, s87, 3
    s_add_u32 s92, s91, 2
    s_add_u32 s91, s91, s9
    s_lshl_b32 s91, s91, 10
    s_lshl_b32 s92, s92, 10
    s_lshl_b32 s87, s87, 10
    s_lshl_b32 s86, s83, 1
    s_add_u32 s86, s86, s99
    s_and_b32 s84, s86, 3
    buffer_load_dwordx4 v21, s[40:43], s78 offen offset:1024  lds
    s_lshl_b32 s84, s84, 7
    s_lshr_b32 s85, s86, 2
    s_lshl_b32 s85, s85, 5
    s_add_u32 s84, s84, s85
    s_lshl_b32 s85, s82, 1
    s_add_u32 s84, s84, s85
    s_add_u32 s84, s84, s98
    s_lshl_b32 s85, s83, 7
    s_lshl_b32 s82, s82, 2
    s_add_u32 s85, s85, s82
    s_add_u32 s85, s85, s99
    s_lshl_b32 s82, s98, 1
    s_add_u32 s85, s85, s82
    s_cmp_lt_u32 s86, 8
    s_cselect_b32 s84, s85, s84
    s_add_u32 m0, s81, 32768
    s_lshl_b32 s84, s84, 10
    buffer_load_dwordx4 v22, s[40:43], s78 offen offset:0  lds
    s_add_u32 s84, s84, 2621440
    s_add_u32 s85, s87, 1572864
    s_add_u32 s87, s87, 2097152
    s_cmp_lt_u32 s2, 128
    s_cselect_b32 s92, s92, s87
    s_cselect_b32 s93, s85, s84
    v_bfe_u32 v5, v3, 1, 3
    v_xor_b32 v5, v5, v4
    v_lshlrev_b32 v5, 4, v5
    v_lshl_add_u32 v5, v3, 7, v5
    s_lshl_b32 s82, s99, 14
    v_add_u32 v200, s82, v5
    v_add_u32 v6, s99, v3
    v_bfe_u32 v5, v6, 1, 3
    v_xor_b32 v5, v5, v4
    v_lshlrev_b32 v5, 4, v5
    v_lshl_add_u32 v5, v6, 7, v5
    buffer_load_dwordx4 v23, s[40:43], s78 offen offset:1024  lds
    s_xor_b32 s82, s99, 1
    s_lshl_b32 s82, s82, 14
    v_add_u32 v202, s82, v5
    v_xor_b32 v201, 64, v200
    v_xor_b32 v203, 64, v202
    v_add_u32 v224, 65536, v200
    v_add_u32 v226, 65536, v202
    v_add_u32 v225, 65536, v201
    v_add_u32 v227, 65536, v203
    v_bfe_u32 v5, v1, 1, 1
    v_bfe_u32 v6, v1, 3, 1
    v_lshl_add_u32 v5, v6, 2, v5
    v_lshlrev_b32 v5, 4, v5
    s_add_u32 m0, s81, 40960
    v_and_b32 v6, 1, v1
    buffer_load_dwordx4 v24, s[40:43], s78 offen offset:0  lds
    v_lshl_add_u32 v5, v6, 3, v5
    v_bfe_u32 v6, v1, 2, 2
    v_lshl_add_u32 v5, v6, 7, v5
    s_lshl_b32 s82, s98, 6
    v_xor_b32 v6, s82, v5
    v_bfe_u32 v7, v1, 4, 1
    v_lshlrev_b32 v7, 5, v7
    v_xor_b32 v6, v6, v7
    v_lshl_add_u32 v6, v4, 10, v6
    v_add_u32 v204, 98304, v6
    v_xor_b32 v206, 32, v204
    v_add_u32 v205, 49152, v204
    v_add_u32 v207, 49152, v206
    s_lshl_b32 s82, s72, 5
    buffer_load_dwordx4 v25, s[40:43], s78 offen offset:1024  lds
    v_xor_b32 v5, s82, v5
    v_lshl_add_u32 v6, v4, 9, v5
    v_add_u32 v27, 147456, v6
    v_lshl_add_u32 v6, v4, 10, v5
    v_add_u32 v6, 147456, v6
    v_and_b32 v7, 3, v1
    v_bfe_u32 v8, v1, 3, 1
    v_lshl_add_u32 v7, v8, 2, v7
    v_lshlrev_b32 v7, 4, v7
    s_lshl_b32 s82, s99, 6
    v_xor_b32 v7, s82, v7
    v_bfe_u32 v8, v1, 2, 2
    v_lshl_add_u32 v7, v8, 7, v7
    s_add_u32 m0, s80, 32768
    v_lshl_add_u32 v7, v4, 10, v7
    buffer_load_dwordx4 v12, s[36:39], s77 offen offset:0  lds
    s_lshl_b32 s82, s98, 3
    s_add_u32 s82, s82, 147456
    v_add_u32 v7, s82, v7
    v_and_b32 v212, 1, v1
    v_lshlrev_b32 v212, 1, v212
    v_bfe_u32 v213, v1, 4, 1
    v_add_u32 v212, v212, v213
    v_bfe_u32 v213, v1, 3, 1
    v_lshl_add_u32 v212, v213, 2, v212
    v_lshlrev_b32 v212, 4, v212
    s_lshl_b32 s82, s99, 6
    v_xor_b32 v212, s82, v212
    v_bfe_u32 v213, v1, 1, 1
    v_lshl_add_u32 v212, v213, 3, v212
    buffer_load_dwordx4 v13, s[36:39], s77 offen offset:1024  lds
    v_bfe_u32 v213, v1, 2, 2
    v_lshl_add_u32 v212, v213, 7, v212
    v_lshrrev_b32 v213, 5, v1
    v_lshl_add_u32 v212, v213, 10, v212
    s_lshl_b32 s82, s98, 11
    s_add_u32 s82, s82, 147456
    v_add_u32 v212, s82, v212
    s_bitcmp0_b32 s86, 3
    s_cselect_b64 vcc, -1, 0
    v_cndmask_b32 v7, v7, v212, vcc
    s_cmp_lt_u32 s2, 128
    s_cselect_b64 vcc, -1, 0
    s_cselect_b32 s82, 4, 1
    v_cndmask_b32 v28, v6, v27, vcc
    v_cndmask_b32 v31, v7, v6, vcc
    s_lshl_b32 s82, s82, 9
    v_add_u32 v29, s82, v28
    s_mul_i32 s82, s75, 8192000
    s_add_u32 s48, s30, s82
    s_addc_u32 s49, s31, 0
    s_add_u32 m0, s80, 34816
    s_nop 0
    buffer_load_dwordx4 v14, s[36:39], s77 offen offset:0  lds
    s_and_b32 s49, s49, 0xffff
    s_mov_b32 s50, 8192000
    s_mov_b32 s51, 0x20000
    s_lshl_b32 s82, s75, 13
    s_add_u32 s68, s22, s82
    s_addc_u32 s69, s23, 0
    s_and_b32 s69, s69, 0xffff
    s_mov_b32 s70, 8192
    s_mov_b32 s71, 0x20000
    s_lshl_b32 s95, s73, 10
    s_add_u32 s95, s95, 14155776
    s_lshl_b32 s82, s74, 7
    s_add_u32 s96, s95, s82
    s_lshl_b32 s82, s72, 2
    s_add_u32 s96, s96, s82
    buffer_load_dwordx4 v15, s[36:39], s77 offen offset:1024  lds
    s_mov_b32 s19, 0
    v_bfe_u32 v5, v1, 2, 3
    v_lshlrev_b32 v5, 7, v5
    v_and_b32 v6, 3, v1
    v_mov_b32 v0, v5
    v_mov_b32 v10, 0xbdd2d3e8
    v_mov_b32 v11, 0xc0135761
    s_getreg_b32 s18, hwreg(HW_REG_XCC_ID, 0, 4)
    s_add_u32 s18, s18, 1
    s_mul_i32 s16, s74, 2
    s_and_b32 s16, s16, 15
    s_mov_b32 s79, s16
    v_and_b32 v5, 31, v1
    v_lshlrev_b32 v209, 3, v5
    s_waitcnt vmcnt(10)
    s_barrier
    s_lshl_b32 s82, s74, 2
    s_add_u32 s82, s82, s72
    s_cmp_eq_u32 s82, 3
    s_cbranch_scc0 L_nd_3
    s_lshl_b32 s82, s73, 3
    v_mov_b32 v5, 1
    v_mov_b32 v6, 0
    s_mov_b64 exec, 1
    buffer_store_dword v5, v6, s[52:55], s82 offen sc1
    s_mov_b64 exec, -1
L_nd_3:
    ds_read_b64_tr_b16 v[136:137], v204 offset:0
    ds_read_b64_tr_b16 v[138:139], v204 offset:512
    ds_read_b128 v[64:67], v200 offset:0
    ds_read_b64_tr_b16 v[140:141], v206 offset:0
    ds_read_b64_tr_b16 v[142:143], v206 offset:512
    ds_read_b128 v[68:71], v200 offset:2048
    ds_read_b64_tr_b16 v[148:149], v206 offset:8192
    ds_read_b64_tr_b16 v[150:151], v206 offset:8704
    ds_read_b64_tr_b16 v[144:145], v204 offset:8192
    s_waitcnt lgkmcnt(6)
    v_mfma_f32_16x16x32_bf16 v[32:35], v[136:139], v[64:67], 0
    ds_read_b64_tr_b16 v[146:147], v204 offset:8704
    s_waitcnt lgkmcnt(5)
    v_mfma_f32_16x16x32_bf16 v[36:39], v[140:143], v[64:67], 0
    ds_read_b128 v[72:75], v200 offset:4096
    s_waitcnt lgkmcnt(3)
    v_mfma_f32_16x16x32_bf16 v[36:39], v[148:151], v[68:71], v[36:39]
    ds_read_b64_tr_b16 v[152:153], v204 offset:16384
    s_waitcnt lgkmcnt(2)
    v_mfma_f32_16x16x32_bf16 v[32:35], v[144:147], v[68:71], v[32:35]
    ds_read_b64_tr_b16 v[154:155], v204 offset:16896
    s_add_u32 m0, s80, 36864
    ds_read_b64_tr_b16 v[156:157], v206 offset:16384
    buffer_load_dwordx4 v16, s[36:39], s77 offen offset:0  lds
    s_waitcnt lgkmcnt(1)
    v_mfma_f32_16x16x32_bf16 v[32:35], v[152:155], v[72:75], v[32:35]
    ds_read_b64_tr_b16 v[158:159], v206 offset:16896
    s_waitcnt lgkmcnt(0)
    v_mfma_f32_16x16x32_bf16 v[36:39], v[156:159], v[72:75], v[36:39]
    ds_read_b128 v[76:79], v200 offset:6144
    ds_read_b128 v[80:83], v200 offset:8192
    buffer_load_dwordx4 v17, s[36:39], s77 offen offset:1024  lds
    v_mfma_f32_16x16x32_bf16 v[40:43], v[136:139], v[72:75], 0
    ds_read_b128 v[84:87], v200 offset:10240
    v_mfma_f32_16x16x32_bf16 v[44:47], v[140:143], v[72:75], 0
    ds_read_b128 v[88:91], v200 offset:12288
    s_add_u32 m0, s80, 38912
    ds_read_b128 v[92:95], v200 offset:14336
    buffer_load_dwordx4 v18, s[36:39], s77 offen offset:0  lds
    s_waitcnt lgkmcnt(4)
    v_mfma_f32_16x16x32_bf16 v[44:47], v[148:151], v[76:79], v[44:47]
    ds_read_b128 v[96:99], v202 offset:0
    v_mfma_f32_16x16x32_bf16 v[40:43], v[144:147], v[76:79], v[40:43]
    ds_read_b64_tr_b16 v[160:161], v204 offset:4096
    buffer_load_dwordx4 v19, s[36:39], s77 offen offset:1024  lds
    s_xor_b32 s77, s14, 2
    s_add_u32 s77, s77, s15
    s_and_b32 s77, s77, 7
    s_lshl_b32 s77, s77, 7
    s_waitcnt lgkmcnt(5)
    v_mfma_f32_16x16x32_bf16 v[40:43], v[152:155], v[80:83], v[40:43]
    ds_read_b64_tr_b16 v[162:163], v204 offset:4608
    ds_read_b128 v[100:103], v201 offset:0
    v_mfma_f32_16x16x32_bf16 v[44:47], v[156:159], v[80:83], v[44:47]
    ds_read_b64_tr_b16 v[164:165], v206 offset:4096
    v_mfma_f32_16x16x32_bf16 v[48:51], v[136:139], v[80:83], 0
    ds_read_b64_tr_b16 v[166:167], v206 offset:4608
    ds_read_b128 v[104:107], v201 offset:2048
    v_mfma_f32_16x16x32_bf16 v[52:55], v[140:143], v[80:83], 0
    ds_read_b64_tr_b16 v[172:173], v206 offset:12288
    s_waitcnt lgkmcnt(10)
    v_mfma_f32_16x16x32_bf16 v[52:55], v[148:151], v[84:87], v[52:55]
    ds_read_b64_tr_b16 v[174:175], v206 offset:12800
    s_add_u32 m0, s80, 65536
    ds_read_b64_tr_b16 v[168:169], v204 offset:12288
    buffer_load_dwordx4 v12, s[36:39], s77 offen offset:0  lds
    v_mfma_f32_16x16x32_bf16 v[48:51], v[144:147], v[84:87], v[48:51]
    ds_read_b64_tr_b16 v[170:171], v204 offset:12800
    s_waitcnt lgkmcnt(12)
    v_mfma_f32_16x16x32_bf16 v[48:51], v[152:155], v[88:91], v[48:51]
    ds_read_b128 v[108:111], v201 offset:4096
    ds_read_b64_tr_b16 v[176:177], v204 offset:20480
    buffer_load_dwordx4 v13, s[36:39], s77 offen offset:1024  lds
    v_mfma_f32_16x16x32_bf16 v[52:55], v[156:159], v[88:91], v[52:55]
    ds_read_b64_tr_b16 v[178:179], v204 offset:20992
    v_mfma_f32_16x16x32_bf16 v[56:59], v[136:139], v[88:91], 0
    ds_read_b64_tr_b16 v[180:181], v206 offset:20480
    v_mfma_f32_16x16x32_bf16 v[60:63], v[140:143], v[88:91], 0
    ds_read_b64_tr_b16 v[182:183], v206 offset:20992
    s_add_u32 m0, s80, 67584
    ds_read_b128 v[112:115], v201 offset:6144
    buffer_load_dwordx4 v14, s[36:39], s77 offen offset:0  lds
    s_waitcnt lgkmcnt(15)
    v_mfma_f32_16x16x32_bf16 v[60:63], v[148:151], v[92:95], v[60:63]
    ds_read_b128 v[116:119], v201 offset:8192
    v_mfma_f32_16x16x32_bf16 v[56:59], v[144:147], v[92:95], v[56:59]
    ds_read_b128 v[120:123], v201 offset:10240
    ds_read_b128 v[124:127], v201 offset:12288
    buffer_load_dwordx4 v15, s[36:39], s77 offen offset:1024  lds
    v_mfma_f32_16x16x32_bf16 v[56:59], v[152:155], v[96:99], v[56:59]
    ds_read_b128 v[128:131], v201 offset:14336
    v_mfma_f32_16x16x32_bf16 v[60:63], v[156:159], v[96:99], v[60:63]
    ds_read_b128 v[132:135], v203 offset:0
    s_add_u32 m0, s80, 69632
    ds_read_b64_tr_b16 v[212:213], v27 offset:0
    buffer_load_dwordx4 v16, s[36:39], s77 offen offset:0  lds
    s_waitcnt lgkmcnt(15)
    v_mfma_f32_16x16x32_bf16 v[32:35], v[160:163], v[100:103], v[32:35]
    ds_read_b64_tr_b16 v[214:215], v27 offset:2048
    v_mfma_f32_16x16x32_bf16 v[36:39], v[164:167], v[100:103], v[36:39]
    ds_read_b64_tr_b16 v[216:217], v28 offset:4096
    ds_read_b64_tr_b16 v[218:219], v29 offset:4096
    s_waitcnt lgkmcnt(15)
    v_mfma_f32_16x16x32_bf16 v[36:39], v[172:175], v[104:107], v[36:39]
    ds_read_b64_tr_b16 v[220:221], v31 offset:8192
    ds_read_b64_tr_b16 v[222:223], v31 offset:8704
    buffer_load_dwordx4 v17, s[36:39], s77 offen offset:1024  lds
    s_add_u32 m0, s80, 71680
    v_mfma_f32_16x16x32_bf16 v[32:35], v[168:171], v[104:107], v[32:35]
    buffer_load_dwordx4 v18, s[36:39], s77 offen offset:0  lds
    s_waitcnt lgkmcnt(14)
    v_mfma_f32_16x16x32_bf16 v[32:35], v[176:179], v[108:111], v[32:35]
    buffer_load_dwordx4 v19, s[36:39], s77 offen offset:1024  lds
    s_waitcnt lgkmcnt(12)
    v_mfma_f32_16x16x32_bf16 v[36:39], v[180:183], v[108:111], v[36:39]
    s_waitcnt vmcnt(8)
    s_waitcnt lgkmcnt(0)
    s_barrier
    v_mfma_f32_16x16x32_bf16 v[40:43], v[160:163], v[108:111], v[40:43]
    ds_read_b64_tr_b16 v[136:137], v204 offset:24576
    s_xor_b32 s78, s14, 2
    s_add_u32 s78, s78, s15
    s_and_b32 s78, s78, 7
    s_lshl_b32 s78, s78, 16
    v_mfma_f32_16x16x32_bf16 v[44:47], v[164:167], v[108:111], v[44:47]
    ds_read_b64_tr_b16 v[138:139], v204 offset:25088
    v_mfma_f32_16x16x32_bf16 v[44:47], v[172:175], v[112:115], v[44:47]
    ds_read_b128 v[64:67], v200 offset:32768
    v_mfma_f32_16x16x32_bf16 v[40:43], v[168:171], v[112:115], v[40:43]
    ds_read_b64_tr_b16 v[140:141], v206 offset:24576
    v_mfma_f32_16x16x32_bf16 v[40:43], v[176:179], v[116:119], v[40:43]
    ds_read_b64_tr_b16 v[142:143], v206 offset:25088
    s_add_u32 m0, s81, 0
    v_mfma_f32_16x16x32_bf16 v[44:47], v[180:183], v[116:119], v[44:47]
    buffer_load_dwordx4 v20, s[40:43], s78 offen offset:0  lds
    v_mfma_f32_16x16x32_bf16 v[48:51], v[160:163], v[116:119], v[48:51]
    ds_read_b128 v[68:71], v200 offset:34816
    v_mfma_f32_16x16x32_bf16 v[52:55], v[164:167], v[116:119], v[52:55]
    ds_read_b64_tr_b16 v[148:149], v206 offset:32768
    v_mfma_f32_16x16x32_bf16 v[52:55], v[172:175], v[120:123], v[52:55]
    ds_read_b64_tr_b16 v[150:151], v206 offset:33280
    buffer_load_dwordx4 v21, s[40:43], s78 offen offset:1024  lds
    v_mfma_f32_16x16x32_bf16 v[48:51], v[168:171], v[120:123], v[48:51]
    ds_read_b64_tr_b16 v[144:145], v204 offset:32768
    v_mfma_f32_16x16x32_bf16 v[48:51], v[176:179], v[124:127], v[48:51]
    s_add_u32 m0, s81, 8192
    ds_read_b64_tr_b16 v[146:147], v204 offset:33280
    buffer_load_dwordx4 v22, s[40:43], s78 offen offset:0  lds
    v_mfma_f32_16x16x32_bf16 v[52:55], v[180:183], v[124:127], v[52:55]
    ds_read_b128 v[72:75], v200 offset:36864
    v_mfma_f32_16x16x32_bf16 v[56:59], v[160:163], v[124:127], v[56:59]
    ds_read_b64_tr_b16 v[152:153], v204 offset:40960
    v_mfma_f32_16x16x32_bf16 v[60:63], v[164:167], v[124:127], v[60:63]
    ds_read_b64_tr_b16 v[154:155], v204 offset:41472
    buffer_load_dwordx4 v23, s[40:43], s78 offen offset:1024  lds
    v_mfma_f32_16x16x32_bf16 v[60:63], v[172:175], v[128:131], v[60:63]
    ds_read_b64_tr_b16 v[156:157], v206 offset:40960
    v_mfma_f32_16x16x32_bf16 v[56:59], v[168:171], v[128:131], v[56:59]
    s_add_u32 m0, s81, 16384
    ds_read_b64_tr_b16 v[158:159], v206 offset:41472
    buffer_load_dwordx4 v24, s[40:43], s78 offen offset:0  lds
    v_mfma_f32_16x16x32_bf16 v[56:59], v[176:179], v[132:135], v[56:59]
    ds_read_b128 v[76:79], v200 offset:38912
    v_mfma_f32_16x16x32_bf16 v[60:63], v[180:183], v[132:135], v[60:63]
    ds_read_b128 v[80:83], v200 offset:40960
    s_nop 0
    s_nop 0
L_PAD0:
    s_cbranch_execz L_PAD4
    buffer_load_dwordx4 v25, s[40:43], s78 offen offset:1024  lds
    s_waitcnt lgkmcnt(14)
    v_mfma_f32_16x16x32_bf16 v[32:35], v[136:139], v[64:67], v[32:35]
    ds_read_b128 v[84:87], v200 offset:43008
    s_waitcnt lgkmcnt(13)
    v_mfma_f32_16x16x32_bf16 v[36:39], v[140:143], v[64:67], v[36:39]
    ds_read_b128 v[88:91], v200 offset:45056
    s_waitcnt lgkmcnt(11)
    v_mfma_f32_16x16x32_bf16 v[36:39], v[148:151], v[68:71], v[36:39]
    ds_read_b128 v[92:95], v200 offset:47104
    s_waitcnt lgkmcnt(10)
    v_mfma_f32_16x16x32_bf16 v[32:35], v[144:147], v[68:71], v[32:35]
    buffer_store_dwordx4 v[212:215], v2, s[44:47], s91 offen sc1
    s_waitcnt lgkmcnt(7)
    v_mfma_f32_16x16x32_bf16 v[32:35], v[152:155], v[72:75], v[32:35]
    ds_read_b128 v[96:99], v202 offset:32768
    s_waitcnt lgkmcnt(6)
    v_mfma_f32_16x16x32_bf16 v[36:39], v[156:159], v[72:75], v[36:39]
    ds_read_b64_tr_b16 v[160:161], v204 offset:28672
    buffer_store_dwordx4 v[216:219], v2, s[44:47], s92 offen sc1
    v_mfma_f32_16x16x32_bf16 v[40:43], v[136:139], v[72:75], v[40:43]
    ds_read_b64_tr_b16 v[162:163], v204 offset:29184
    v_mfma_f32_16x16x32_bf16 v[44:47], v[140:143], v[72:75], v[44:47]
    ds_read_b128 v[100:103], v201 offset:32768
    s_waitcnt lgkmcnt(8)
    v_mfma_f32_16x16x32_bf16 v[44:47], v[148:151], v[76:79], v[44:47]
    ds_read_b64_tr_b16 v[164:165], v206 offset:28672
    buffer_store_dwordx4 v[220:223], v2, s[44:47], s93 offen sc1
    s_xor_b32 s77, s14, 3
    s_add_u32 s77, s77, s15
    s_and_b32 s77, s77, 7
    s_lshl_b32 s77, s77, 7
    v_mfma_f32_16x16x32_bf16 v[40:43], v[144:147], v[76:79], v[40:43]
    ds_read_b64_tr_b16 v[166:167], v206 offset:29184
    s_waitcnt lgkmcnt(9)
    v_mfma_f32_16x16x32_bf16 v[40:43], v[152:155], v[80:83], v[40:43]
    ds_read_b128 v[104:107], v201 offset:34816
    v_mfma_f32_16x16x32_bf16 v[44:47], v[156:159], v[80:83], v[44:47]
    ds_read_b64_tr_b16 v[172:173], v206 offset:36864
    v_mfma_f32_16x16x32_bf16 v[48:51], v[136:139], v[80:83], v[48:51]
    ds_read_b64_tr_b16 v[174:175], v206 offset:37376
    v_mfma_f32_16x16x32_bf16 v[52:55], v[140:143], v[80:83], v[52:55]
    s_add_u32 m0, s80, 0
    ds_read_b64_tr_b16 v[168:169], v204 offset:36864
    buffer_load_dwordx4 v12, s[36:39], s77 offen offset:0  lds
    s_waitcnt lgkmcnt(12)
    v_mfma_f32_16x16x32_bf16 v[52:55], v[148:151], v[84:87], v[52:55]
    ds_read_b64_tr_b16 v[170:171], v204 offset:37376
    v_mfma_f32_16x16x32_bf16 v[48:51], v[144:147], v[84:87], v[48:51]
    buffer_load_dwordx4 v13, s[36:39], s77 offen offset:1024  lds
    s_waitcnt lgkmcnt(12)
    v_mfma_f32_16x16x32_bf16 v[48:51], v[152:155], v[88:91], v[48:51]
    ds_read_b128 v[108:111], v201 offset:36864
    v_mfma_f32_16x16x32_bf16 v[52:55], v[156:159], v[88:91], v[52:55]
    ds_read_b64_tr_b16 v[176:177], v204 offset:45056
    v_mfma_f32_16x16x32_bf16 v[56:59], v[136:139], v[88:91], v[56:59]
    s_add_u32 m0, s80, 2048
    ds_read_b64_tr_b16 v[178:179], v204 offset:45568
    buffer_load_dwordx4 v14, s[36:39], s77 offen offset:0  lds
    v_mfma_f32_16x16x32_bf16 v[60:63], v[140:143], v[88:91], v[60:63]
    ds_read_b64_tr_b16 v[180:181], v206 offset:45056
    s_waitcnt lgkmcnt(15)
    v_mfma_f32_16x16x32_bf16 v[60:63], v[148:151], v[92:95], v[60:63]
    ds_read_b64_tr_b16 v[182:183], v206 offset:45568
    buffer_load_dwordx4 v15, s[36:39], s77 offen offset:1024  lds
    v_mfma_f32_16x16x32_bf16 v[56:59], v[144:147], v[92:95], v[56:59]
    ds_read_b128 v[112:115], v201 offset:38912
    s_waitcnt lgkmcnt(15)
    v_mfma_f32_16x16x32_bf16 v[56:59], v[152:155], v[96:99], v[56:59]
    ds_read_b128 v[116:119], v201 offset:40960
    v_mfma_f32_16x16x32_bf16 v[60:63], v[156:159], v[96:99], v[60:63]
    s_add_u32 m0, s80, 4096
    ds_read_b128 v[120:123], v201 offset:43008
    buffer_load_dwordx4 v16, s[36:39], s77 offen offset:0  lds
    s_waitcnt lgkmcnt(15)
    v_mfma_f32_16x16x32_bf16 v[32:35], v[160:163], v[100:103], v[32:35]
    ds_read_b128 v[124:127], v201 offset:45056
    s_waitcnt lgkmcnt(14)
    v_mfma_f32_16x16x32_bf16 v[36:39], v[164:167], v[100:103], v[36:39]
    ds_read_b128 v[128:131], v201 offset:47104
    buffer_load_dwordx4 v17, s[36:39], s77 offen offset:1024  lds
    s_waitcnt lgkmcnt(12)
    v_mfma_f32_16x16x32_bf16 v[36:39], v[172:175], v[104:107], v[36:39]
    ds_read_b128 v[132:135], v203 offset:32768
    s_waitcnt lgkmcnt(11)
    s_add_u32 m0, s80, 6144
    v_mfma_f32_16x16x32_bf16 v[32:35], v[168:171], v[104:107], v[32:35]
    buffer_load_dwordx4 v18, s[36:39], s77 offen offset:0  lds
    s_waitcnt lgkmcnt(8)
    v_mfma_f32_16x16x32_bf16 v[32:35], v[176:179], v[108:111], v[32:35]
    buffer_load_dwordx4 v19, s[36:39], s77 offen offset:1024  lds
    s_waitcnt lgkmcnt(6)
    v_mfma_f32_16x16x32_bf16 v[36:39], v[180:183], v[108:111], v[36:39]
    s_waitcnt vmcnt(11)
    s_waitcnt lgkmcnt(0)
    s_barrier
    v_mfma_f32_16x16x32_bf16 v[40:43], v[160:163], v[108:111], v[40:43]
    ds_read_b64_tr_b16 v[136:137], v204 offset:0
    s_xor_b32 s78, s14, 3
    s_add_u32 s78, s78, s15
    s_and_b32 s78, s78, 7
    s_lshl_b32 s78, s78, 16
    v_mfma_f32_16x16x32_bf16 v[44:47], v[164:167], v[108:111], v[44:47]
    ds_read_b64_tr_b16 v[138:139], v204 offset:512
    v_mfma_f32_16x16x32_bf16 v[44:47], v[172:175], v[112:115], v[44:47]
    ds_read_b128 v[64:67], v224 offset:0
    v_mfma_f32_16x16x32_bf16 v[40:43], v[168:171], v[112:115], v[40:43]
    ds_read_b64_tr_b16 v[140:141], v206 offset:0
    v_mfma_f32_16x16x32_bf16 v[40:43], v[176:179], v[116:119], v[40:43]
    ds_read_b64_tr_b16 v[142:143], v206 offset:512
    s_add_u32 m0, s81, 24576
    v_mfma_f32_16x16x32_bf16 v[44:47], v[180:183], v[116:119], v[44:47]
    buffer_load_dwordx4 v20, s[40:43], s78 offen offset:0  lds
    v_mfma_f32_16x16x32_bf16 v[48:51], v[160:163], v[116:119], v[48:51]
    ds_read_b128 v[68:71], v224 offset:2048
    v_mfma_f32_16x16x32_bf16 v[52:55], v[164:167], v[116:119], v[52:55]
    ds_read_b64_tr_b16 v[148:149], v206 offset:8192
    buffer_load_dwordx4 v21, s[40:43], s78 offen offset:1024  lds
    v_mfma_f32_16x16x32_bf16 v[52:55], v[172:175], v[120:123], v[52:55]
    ds_read_b64_tr_b16 v[150:151], v206 offset:8704
    v_mfma_f32_16x16x32_bf16 v[48:51], v[168:171], v[120:123], v[48:51]
    s_add_u32 m0, s81, 32768
    ds_read_b64_tr_b16 v[144:145], v204 offset:8192
    buffer_load_dwordx4 v22, s[40:43], s78 offen offset:0  lds
    v_mfma_f32_16x16x32_bf16 v[48:51], v[176:179], v[124:127], v[48:51]
    ds_read_b64_tr_b16 v[146:147], v204 offset:8704
    v_mfma_f32_16x16x32_bf16 v[52:55], v[180:183], v[124:127], v[52:55]
    ds_read_b128 v[72:75], v224 offset:4096
    v_mfma_f32_16x16x32_bf16 v[56:59], v[160:163], v[124:127], v[56:59]
    ds_read_b64_tr_b16 v[152:153], v204 offset:16384
    buffer_load_dwordx4 v23, s[40:43], s78 offen offset:1024  lds
    v_mfma_f32_16x16x32_bf16 v[60:63], v[164:167], v[124:127], v[60:63]
    ds_read_b64_tr_b16 v[154:155], v204 offset:16896
    v_mfma_f32_16x16x32_bf16 v[60:63], v[172:175], v[128:131], v[60:63]
    s_add_u32 m0, s81, 40960
    ds_read_b64_tr_b16 v[156:157], v206 offset:16384
    buffer_load_dwordx4 v24, s[40:43], s78 offen offset:0  lds
    v_mfma_f32_16x16x32_bf16 v[56:59], v[168:171], v[128:131], v[56:59]
    ds_read_b64_tr_b16 v[158:159], v206 offset:16896
    v_mfma_f32_16x16x32_bf16 v[56:59], v[176:179], v[132:135], v[56:59]
    ds_read_b128 v[76:79], v224 offset:6144
    buffer_load_dwordx4 v25, s[40:43], s78 offen offset:1024  lds
    v_mfma_f32_16x16x32_bf16 v[60:63], v[180:183], v[132:135], v[60:63]
    ds_read_b128 v[80:83], v224 offset:8192
    buffer_load_dword v208, v209, s[52:55], 0 offen sc1
    s_waitcnt lgkmcnt(14)
    v_mfma_f32_16x16x32_bf16 v[32:35], v[136:139], v[64:67], v[32:35]
    ds_read_b128 v[84:87], v224 offset:10240
    s_xor_b32 s77, s14, 4
    s_add_u32 s77, s77, s15
    s_and_b32 s77, s77, 7
    s_lshl_b32 s77, s77, 7
    s_waitcnt lgkmcnt(13)
    v_mfma_f32_16x16x32_bf16 v[36:39], v[140:143], v[64:67], v[36:39]
    ds_read_b128 v[88:91], v224 offset:12288
    s_waitcnt lgkmcnt(11)
    v_mfma_f32_16x16x32_bf16 v[36:39], v[148:151], v[68:71], v[36:39]
    ds_read_b128 v[92:95], v224 offset:14336
    s_waitcnt lgkmcnt(10)
    v_mfma_f32_16x16x32_bf16 v[32:35], v[144:147], v[68:71], v[32:35]
    ds_read_b128 v[96:99], v226 offset:0
    s_waitcnt lgkmcnt(8)
    v_mfma_f32_16x16x32_bf16 v[32:35], v[152:155], v[72:75], v[32:35]
    ds_read_b64_tr_b16 v[160:161], v204 offset:4096
    s_waitcnt lgkmcnt(7)
    s_add_u32 m0, s80, 32768
    v_mfma_f32_16x16x32_bf16 v[36:39], v[156:159], v[72:75], v[36:39]
    buffer_load_dwordx4 v12, s[36:39], s77 offen offset:0  lds
    v_mfma_f32_16x16x32_bf16 v[40:43], v[136:139], v[72:75], v[40:43]
    ds_read_b64_tr_b16 v[162:163], v204 offset:4608
    v_mfma_f32_16x16x32_bf16 v[44:47], v[140:143], v[72:75], v[44:47]
    ds_read_b128 v[100:103], v225 offset:0
    s_waitcnt lgkmcnt(8)
    v_mfma_f32_16x16x32_bf16 v[44:47], v[148:151], v[76:79], v[44:47]
    ds_read_b64_tr_b16 v[164:165], v206 offset:4096
    buffer_load_dwordx4 v13, s[36:39], s77 offen offset:1024  lds
    v_mfma_f32_16x16x32_bf16 v[40:43], v[144:147], v[76:79], v[40:43]
    ds_read_b64_tr_b16 v[166:167], v206 offset:4608
    s_waitcnt lgkmcnt(9)
    v_mfma_f32_16x16x32_bf16 v[40:43], v[152:155], v[80:83], v[40:43]
    ds_read_b128 v[104:107], v225 offset:2048
    v_mfma_f32_16x16x32_bf16 v[44:47], v[156:159], v[80:83], v[44:47]
    s_add_u32 m0, s80, 34816
    ds_read_b64_tr_b16 v[172:173], v206 offset:12288
    buffer_load_dwordx4 v14, s[36:39], s77 offen offset:0  lds
    v_mfma_f32_16x16x32_bf16 v[48:51], v[136:139], v[80:83], v[48:51]
    ds_read_b64_tr_b16 v[174:175], v206 offset:12800
    v_mfma_f32_16x16x32_bf16 v[52:55], v[140:143], v[80:83], v[52:55]
    ds_read_b64_tr_b16 v[168:169], v204 offset:12288
    buffer_load_dwordx4 v15, s[36:39], s77 offen offset:1024  lds
    s_waitcnt lgkmcnt(12)
    v_mfma_f32_16x16x32_bf16 v[52:55], v[148:151], v[84:87], v[52:55]
    ds_read_b64_tr_b16 v[170:171], v204 offset:12800
    v_mfma_f32_16x16x32_bf16 v[48:51], v[144:147], v[84:87], v[48:51]
    ds_read_b128 v[108:111], v225 offset:4096
    s_waitcnt lgkmcnt(13)
    s_add_u32 m0, s80, 36864
    v_mfma_f32_16x16x32_bf16 v[48:51], v[152:155], v[88:91], v[48:51]
    buffer_load_dwordx4 v16, s[36:39], s77 offen offset:0  lds
    v_mfma_f32_16x16x32_bf16 v[52:55], v[156:159], v[88:91], v[52:55]
    ds_read_b64_tr_b16 v[176:177], v204 offset:20480
    v_mfma_f32_16x16x32_bf16 v[56:59], v[136:139], v[88:91], v[56:59]
    ds_read_b64_tr_b16 v[178:179], v204 offset:20992
    v_mfma_f32_16x16x32_bf16 v[60:63], v[140:143], v[88:91], v[60:63]
    ds_read_b64_tr_b16 v[180:181], v206 offset:20480
    buffer_load_dwordx4 v17, s[36:39], s77 offen offset:1024  lds
    s_waitcnt lgkmcnt(15)
    v_mfma_f32_16x16x32_bf16 v[60:63], v[148:151], v[92:95], v[60:63]
    ds_read_b64_tr_b16 v[182:183], v206 offset:20992
    v_mfma_f32_16x16x32_bf16 v[56:59], v[144:147], v[92:95], v[56:59]
    ds_read_b128 v[112:115], v225 offset:6144
    s_waitcnt lgkmcnt(15)
    v_mfma_f32_16x16x32_bf16 v[56:59], v[152:155], v[96:99], v[56:59]
    s_add_u32 m0, s80, 38912
    ds_read_b128 v[116:119], v225 offset:8192
    buffer_load_dwordx4 v18, s[36:39], s77 offen offset:0  lds
    v_mfma_f32_16x16x32_bf16 v[60:63], v[156:159], v[96:99], v[60:63]
    ds_read_b128 v[120:123], v225 offset:10240
    s_waitcnt lgkmcnt(15)
    v_mfma_f32_16x16x32_bf16 v[32:35], v[160:163], v[100:103], v[32:35]
    ds_read_b128 v[124:127], v225 offset:12288
    buffer_load_dwordx4 v19, s[36:39], s77 offen offset:1024  lds
    s_waitcnt lgkmcnt(14)
    v_mfma_f32_16x16x32_bf16 v[36:39], v[164:167], v[100:103], v[36:39]
    ds_read_b128 v[128:131], v225 offset:14336
    s_waitcnt lgkmcnt(12)
    v_mfma_f32_16x16x32_bf16 v[36:39], v[172:175], v[104:107], v[36:39]
    ds_read_b128 v[132:135], v227 offset:0
    s_waitcnt lgkmcnt(11)
    v_mfma_f32_16x16x32_bf16 v[32:35], v[168:171], v[104:107], v[32:35]
    s_lshl_b32 s85, s72, 11
    s_mul_i32 s86, s72, 2112
    s_add_u32 m0, s86, 147456
    s_nop 0
    buffer_load_dwordx4 v2, s[68:71], s85 offen lds
    s_waitcnt lgkmcnt(8)
    s_add_u32 m0, s86, 147488
    v_mfma_f32_16x16x32_bf16 v[32:35], v[176:179], v[108:111], v[32:35]
    buffer_load_dwordx4 v2, s[68:71], s85 offen offset:1024 lds
    s_waitcnt lgkmcnt(6)
    v_mfma_f32_16x16x32_bf16 v[36:39], v[180:183], v[108:111], v[36:39]
    s_waitcnt vmcnt(10)
    s_waitcnt lgkmcnt(0)
    s_barrier
    s_cmp_eq_u32 s72, 0
    s_cbranch_scc0 L_np_4
    s_mov_b32 s94, 60000
L_dp_5:
    v_cmp_eq_u32 vcc, 1, v208
    s_nop 0
    s_bitcmp1_b32 vcc_lo, s73
    s_cbranch_scc1 L_dd_6
    buffer_load_dword v208, v209, s[52:55], 0 offen sc1
    s_waitcnt vmcnt(0)
    s_sub_u32 s94, s94, 1
    s_cmp_lg_u32 s94, 0
    s_cbranch_scc1 L_dp_5
L_dd_6:
    s_lshl_b32 s82, s73, 7
    s_lshl_b32 s83, s74, 2
    s_add_u32 s82, s82, s83
    s_add_u32 s82, s82, 14221312
    v_mov_b32 v5, s18
    v_mov_b32 v6, 0
    s_mov_b64 exec, 1
    buffer_store_dword v5, v6, s[44:47], s82 offen sc1
    s_mov_b64 exec, -1
L_np_4:
    v_mfma_f32_16x16x32_bf16 v[40:43], v[160:163], v[108:111], v[40:43]
    ds_read_b64_tr_b16 v[136:137], v204 offset:24576
    s_xor_b32 s78, s14, 4
    s_add_u32 s78, s78, s15
    s_and_b32 s78, s78, 7
    s_lshl_b32 s78, s78, 16
    v_mfma_f32_16x16x32_bf16 v[44:47], v[164:167], v[108:111], v[44:47]
    ds_read_b64_tr_b16 v[138:139], v204 offset:25088
    v_mfma_f32_16x16x32_bf16 v[44:47], v[172:175], v[112:115], v[44:47]
    ds_read_b128 v[64:67], v200 offset:0
    v_mfma_f32_16x16x32_bf16 v[40:43], v[168:171], v[112:115], v[40:43]
    ds_read_b64_tr_b16 v[140:141], v206 offset:24576
    v_mfma_f32_16x16x32_bf16 v[40:43], v[176:179], v[116:119], v[40:43]
    ds_read_b64_tr_b16 v[142:143], v206 offset:25088
    s_add_u32 m0, s81, 0
    v_mfma_f32_16x16x32_bf16 v[44:47], v[180:183], v[116:119], v[44:47]
    buffer_load_dwordx4 v20, s[40:43], s78 offen offset:0  lds
    v_mfma_f32_16x16x32_bf16 v[48:51], v[160:163], v[116:119], v[48:51]
    ds_read_b128 v[68:71], v200 offset:2048
    v_mfma_f32_16x16x32_bf16 v[52:55], v[164:167], v[116:119], v[52:55]
    ds_read_b64_tr_b16 v[148:149], v206 offset:32768
    v_mfma_f32_16x16x32_bf16 v[52:55], v[172:175], v[120:123], v[52:55]
    ds_read_b64_tr_b16 v[150:151], v206 offset:33280
    buffer_load_dwordx4 v21, s[40:43], s78 offen offset:1024  lds
    v_mfma_f32_16x16x32_bf16 v[48:51], v[168:171], v[120:123], v[48:51]
    ds_read_b64_tr_b16 v[144:145], v204 offset:32768
    v_mfma_f32_16x16x32_bf16 v[48:51], v[176:179], v[124:127], v[48:51]
    s_add_u32 m0, s81, 8192
    ds_read_b64_tr_b16 v[146:147], v204 offset:33280
    buffer_load_dwordx4 v22, s[40:43], s78 offen offset:0  lds
    v_mfma_f32_16x16x32_bf16 v[52:55], v[180:183], v[124:127], v[52:55]
    ds_read_b128 v[72:75], v200 offset:4096
    v_mfma_f32_16x16x32_bf16 v[56:59], v[160:163], v[124:127], v[56:59]
    ds_read_b64_tr_b16 v[152:153], v204 offset:40960
    v_mfma_f32_16x16x32_bf16 v[60:63], v[164:167], v[124:127], v[60:63]
    ds_read_b64_tr_b16 v[154:155], v204 offset:41472
    buffer_load_dwordx4 v23, s[40:43], s78 offen offset:1024  lds
    v_mfma_f32_16x16x32_bf16 v[60:63], v[172:175], v[128:131], v[60:63]
    ds_read_b64_tr_b16 v[156:157], v206 offset:40960
    v_mfma_f32_16x16x32_bf16 v[56:59], v[168:171], v[128:131], v[56:59]
    s_add_u32 m0, s81, 16384
    ds_read_b64_tr_b16 v[158:159], v206 offset:41472
    buffer_load_dwordx4 v24, s[40:43], s78 offen offset:0  lds
    v_mfma_f32_16x16x32_bf16 v[56:59], v[176:179], v[132:135], v[56:59]
    ds_read_b128 v[76:79], v200 offset:6144
    v_mfma_f32_16x16x32_bf16 v[60:63], v[180:183], v[132:135], v[60:63]
    ds_read_b128 v[80:83], v200 offset:8192
    buffer_load_dwordx4 v25, s[40:43], s78 offen offset:1024  lds
    s_waitcnt lgkmcnt(14)
    v_mfma_f32_16x16x32_bf16 v[32:35], v[136:139], v[64:67], v[32:35]
    ds_read_b128 v[84:87], v200 offset:10240
    s_xor_b32 s77, s14, 5
    s_add_u32 s77, s77, s15
    s_and_b32 s77, s77, 7
    s_lshl_b32 s77, s77, 7
    s_waitcnt lgkmcnt(13)
    v_mfma_f32_16x16x32_bf16 v[36:39], v[140:143], v[64:67], v[36:39]
    ds_read_b128 v[88:91], v200 offset:12288
    s_waitcnt lgkmcnt(11)
    v_mfma_f32_16x16x32_bf16 v[36:39], v[148:151], v[68:71], v[36:39]
    ds_read_b128 v[92:95], v200 offset:14336
    s_waitcnt lgkmcnt(10)
    v_mfma_f32_16x16x32_bf16 v[32:35], v[144:147], v[68:71], v[32:35]
    ds_read_b128 v[96:99], v202 offset:0
    s_waitcnt lgkmcnt(8)
    v_mfma_f32_16x16x32_bf16 v[32:35], v[152:155], v[72:75], v[32:35]
    ds_read_b64_tr_b16 v[160:161], v204 offset:28672
    s_waitcnt lgkmcnt(7)
    v_mfma_f32_16x16x32_bf16 v[36:39], v[156:159], v[72:75], v[36:39]
    ds_read_b64_tr_b16 v[162:163], v204 offset:29184
    s_add_u32 m0, s80, 65536
    v_mfma_f32_16x16x32_bf16 v[40:43], v[136:139], v[72:75], v[40:43]
    buffer_load_dwordx4 v12, s[36:39], s77 offen offset:0  lds
    v_mfma_f32_16x16x32_bf16 v[44:47], v[140:143], v[72:75], v[44:47]
    ds_read_b128 v[100:103], v201 offset:0
    s_waitcnt lgkmcnt(8)
    v_mfma_f32_16x16x32_bf16 v[44:47], v[148:151], v[76:79], v[44:47]
    ds_read_b64_tr_b16 v[164:165], v206 offset:28672
    v_mfma_f32_16x16x32_bf16 v[40:43], v[144:147], v[76:79], v[40:43]
    ds_read_b64_tr_b16 v[166:167], v206 offset:29184
    buffer_load_dwordx4 v13, s[36:39], s77 offen offset:1024  lds
    s_waitcnt lgkmcnt(9)
    v_mfma_f32_16x16x32_bf16 v[40:43], v[152:155], v[80:83], v[40:43]
    ds_read_b128 v[104:107], v201 offset:2048
    v_mfma_f32_16x16x32_bf16 v[44:47], v[156:159], v[80:83], v[44:47]
    ds_read_b64_tr_b16 v[172:173], v206 offset:36864
    v_mfma_f32_16x16x32_bf16 v[48:51], v[136:139], v[80:83], v[48:51]
    ds_read_b64_tr_b16 v[174:175], v206 offset:37376
    v_mfma_f32_16x16x32_bf16 v[52:55], v[140:143], v[80:83], v[52:55]
    s_add_u32 m0, s80, 67584
    ds_read_b64_tr_b16 v[168:169], v204 offset:36864
    buffer_load_dwordx4 v14, s[36:39], s77 offen offset:0  lds
    s_waitcnt lgkmcnt(12)
    v_mfma_f32_16x16x32_bf16 v[52:55], v[148:151], v[84:87], v[52:55]
    ds_read_b64_tr_b16 v[170:171], v204 offset:37376
    v_mfma_f32_16x16x32_bf16 v[48:51], v[144:147], v[84:87], v[48:51]
    ds_read_b128 v[108:111], v201 offset:4096
    s_waitcnt lgkmcnt(13)
    v_mfma_f32_16x16x32_bf16 v[48:51], v[152:155], v[88:91], v[48:51]
    buffer_load_dwordx4 v15, s[36:39], s77 offen offset:1024  lds
    v_mfma_f32_16x16x32_bf16 v[52:55], v[156:159], v[88:91], v[52:55]
    ds_read_b64_tr_b16 v[176:177], v204 offset:45056
    v_mfma_f32_16x16x32_bf16 v[56:59], v[136:139], v[88:91], v[56:59]
    ds_read_b64_tr_b16 v[178:179], v204 offset:45568
    v_mfma_f32_16x16x32_bf16 v[60:63], v[140:143], v[88:91], v[60:63]
    s_add_u32 m0, s80, 69632
    ds_read_b64_tr_b16 v[180:181], v206 offset:45056
    buffer_load_dwordx4 v16, s[36:39], s77 offen offset:0  lds
    s_waitcnt lgkmcnt(15)
    v_mfma_f32_16x16x32_bf16 v[60:63], v[148:151], v[92:95], v[60:63]
    ds_read_b64_tr_b16 v[182:183], v206 offset:45568
    v_mfma_f32_16x16x32_bf16 v[56:59], v[144:147], v[92:95], v[56:59]
    ds_read_b128 v[112:115], v201 offset:6144
    s_waitcnt lgkmcnt(15)
    v_mfma_f32_16x16x32_bf16 v[56:59], v[152:155], v[96:99], v[56:59]
    ds_read_b128 v[116:119], v201 offset:8192
    v_mfma_f32_16x16x32_bf16 v[60:63], v[156:159], v[96:99], v[60:63]
    ds_read_b128 v[120:123], v201 offset:10240
    buffer_load_dwordx4 v17, s[36:39], s77 offen offset:1024  lds
    s_waitcnt lgkmcnt(15)
    v_mfma_f32_16x16x32_bf16 v[32:35], v[160:163], v[100:103], v[32:35]
    ds_read_b128 v[124:127], v201 offset:12288
    s_waitcnt lgkmcnt(14)
    v_mfma_f32_16x16x32_bf16 v[36:39], v[164:167], v[100:103], v[36:39]
    ds_read_b128 v[128:131], v201 offset:14336
    s_waitcnt lgkmcnt(12)
    v_mfma_f32_16x16x32_bf16 v[36:39], v[172:175], v[104:107], v[36:39]
    s_add_u32 m0, s80, 71680
    ds_read_b128 v[132:135], v203 offset:0
    buffer_load_dwordx4 v18, s[36:39], s77 offen offset:0  lds
    s_waitcnt lgkmcnt(11)
    v_mfma_f32_16x16x32_bf16 v[32:35], v[168:171], v[104:107], v[32:35]
    buffer_load_dwordx4 v19, s[36:39], s77 offen offset:1024  lds
    s_waitcnt lgkmcnt(8)
    v_mfma_f32_16x16x32_bf16 v[32:35], v[176:179], v[108:111], v[32:35]
    s_waitcnt lgkmcnt(6)
    v_mfma_f32_16x16x32_bf16 v[36:39], v[180:183], v[108:111], v[36:39]
    s_waitcnt vmcnt(8)
    s_waitcnt lgkmcnt(0)
    s_barrier
    v_mfma_f32_16x16x32_bf16 v[40:43], v[160:163], v[108:111], v[40:43]
    ds_read_b64_tr_b16 v[136:137], v204 offset:0
    s_xor_b32 s78, s14, 5
    s_add_u32 s78, s78, s15
    s_and_b32 s78, s78, 7
    s_lshl_b32 s78, s78, 16
    v_mfma_f32_16x16x32_bf16 v[44:47], v[164:167], v[108:111], v[44:47]
    ds_read_b64_tr_b16 v[138:139], v204 offset:512
    v_mfma_f32_16x16x32_bf16 v[44:47], v[172:175], v[112:115], v[44:47]
    ds_read_b128 v[64:67], v200 offset:32768
    v_mfma_f32_16x16x32_bf16 v[40:43], v[168:171], v[112:115], v[40:43]
    ds_read_b64_tr_b16 v[140:141], v206 offset:0
    v_mfma_f32_16x16x32_bf16 v[40:43], v[176:179], v[116:119], v[40:43]
    ds_read_b64_tr_b16 v[142:143], v206 offset:512
    s_add_u32 m0, s81, 24576
    v_mfma_f32_16x16x32_bf16 v[44:47], v[180:183], v[116:119], v[44:47]
    buffer_load_dwordx4 v20, s[40:43], s78 offen offset:0  lds
    v_mfma_f32_16x16x32_bf16 v[48:51], v[160:163], v[116:119], v[48:51]
    ds_read_b128 v[68:71], v200 offset:34816
    v_mfma_f32_16x16x32_bf16 v[52:55], v[164:167], v[116:119], v[52:55]
    ds_read_b64_tr_b16 v[148:149], v206 offset:8192
    buffer_load_dwordx4 v21, s[40:43], s78 offen offset:1024  lds
    v_mfma_f32_16x16x32_bf16 v[52:55], v[172:175], v[120:123], v[52:55]
    ds_read_b64_tr_b16 v[150:151], v206 offset:8704
    v_mfma_f32_16x16x32_bf16 v[48:51], v[168:171], v[120:123], v[48:51]
    s_add_u32 m0, s81, 32768
    ds_read_b64_tr_b16 v[144:145], v204 offset:8192
    buffer_load_dwordx4 v22, s[40:43], s78 offen offset:0  lds
    v_mfma_f32_16x16x32_bf16 v[48:51], v[176:179], v[124:127], v[48:51]
    ds_read_b64_tr_b16 v[146:147], v204 offset:8704
    v_mfma_f32_16x16x32_bf16 v[52:55], v[180:183], v[124:127], v[52:55]
    ds_read_b128 v[72:75], v200 offset:36864
    v_mfma_f32_16x16x32_bf16 v[56:59], v[160:163], v[124:127], v[56:59]
    ds_read_b64_tr_b16 v[152:153], v204 offset:16384
    buffer_load_dwordx4 v23, s[40:43], s78 offen offset:1024  lds
    v_mfma_f32_16x16x32_bf16 v[60:63], v[164:167], v[124:127], v[60:63]
    ds_read_b64_tr_b16 v[154:155], v204 offset:16896
    v_mfma_f32_16x16x32_bf16 v[60:63], v[172:175], v[128:131], v[60:63]
    s_add_u32 m0, s81, 40960
    ds_read_b64_tr_b16 v[156:157], v206 offset:16384
    buffer_load_dwordx4 v24, s[40:43], s78 offen offset:0  lds
    v_mfma_f32_16x16x32_bf16 v[56:59], v[168:171], v[128:131], v[56:59]
    ds_read_b64_tr_b16 v[158:159], v206 offset:16896
    v_mfma_f32_16x16x32_bf16 v[56:59], v[176:179], v[132:135], v[56:59]
    ds_read_b128 v[76:79], v200 offset:38912
    buffer_load_dwordx4 v25, s[40:43], s78 offen offset:1024  lds
    v_mfma_f32_16x16x32_bf16 v[60:63], v[180:183], v[132:135], v[60:63]
    ds_read_b128 v[80:83], v200 offset:40960
    buffer_load_dword v208, v209, s[52:55], 0 offen sc1
    s_waitcnt lgkmcnt(14)
    v_mfma_f32_16x16x32_bf16 v[32:35], v[136:139], v[64:67], v[32:35]
    ds_read_b128 v[84:87], v200 offset:43008
    s_xor_b32 s77, s14, 6
    s_add_u32 s77, s77, s15
    s_and_b32 s77, s77, 7
    s_lshl_b32 s77, s77, 7
    s_waitcnt lgkmcnt(13)
    v_mfma_f32_16x16x32_bf16 v[36:39], v[140:143], v[64:67], v[36:39]
    ds_read_b128 v[88:91], v200 offset:45056
    s_waitcnt lgkmcnt(11)
    v_mfma_f32_16x16x32_bf16 v[36:39], v[148:151], v[68:71], v[36:39]
    ds_read_b128 v[92:95], v200 offset:47104
    s_waitcnt lgkmcnt(10)
    v_mfma_f32_16x16x32_bf16 v[32:35], v[144:147], v[68:71], v[32:35]
    ds_read_b128 v[96:99], v202 offset:32768
    s_waitcnt lgkmcnt(8)
    v_mfma_f32_16x16x32_bf16 v[32:35], v[152:155], v[72:75], v[32:35]
    ds_read_b64_tr_b16 v[160:161], v204 offset:4096
    s_waitcnt lgkmcnt(7)
    v_mfma_f32_16x16x32_bf16 v[36:39], v[156:159], v[72:75], v[36:39]
    ds_read_b64_tr_b16 v[162:163], v204 offset:4608
    s_add_u32 m0, s80, 0
    v_mfma_f32_16x16x32_bf16 v[40:43], v[136:139], v[72:75], v[40:43]
    buffer_load_dwordx4 v12, s[36:39], s77 offen offset:0  lds
    v_mfma_f32_16x16x32_bf16 v[44:47], v[140:143], v[72:75], v[44:47]
    ds_read_b128 v[100:103], v201 offset:32768
    s_waitcnt lgkmcnt(8)
    v_mfma_f32_16x16x32_bf16 v[44:47], v[148:151], v[76:79], v[44:47]
    ds_read_b64_tr_b16 v[164:165], v206 offset:4096
    v_mfma_f32_16x16x32_bf16 v[40:43], v[144:147], v[76:79], v[40:43]
    ds_read_b64_tr_b16 v[166:167], v206 offset:4608
    buffer_load_dwordx4 v13, s[36:39], s77 offen offset:1024  lds
    s_waitcnt lgkmcnt(9)
    v_mfma_f32_16x16x32_bf16 v[40:43], v[152:155], v[80:83], v[40:43]
    ds_read_b128 v[104:107], v201 offset:34816
    v_mfma_f32_16x16x32_bf16 v[44:47], v[156:159], v[80:83], v[44:47]
    ds_read_b64_tr_b16 v[172:173], v206 offset:12288
    v_mfma_f32_16x16x32_bf16 v[48:51], v[136:139], v[80:83], v[48:51]
    ds_read_b64_tr_b16 v[174:175], v206 offset:12800
    v_mfma_f32_16x16x32_bf16 v[52:55], v[140:143], v[80:83], v[52:55]
    s_add_u32 m0, s80, 2048
    ds_read_b64_tr_b16 v[168:169], v204 offset:12288
    buffer_load_dwordx4 v14, s[36:39], s77 offen offset:0  lds
    s_waitcnt lgkmcnt(12)
    v_mfma_f32_16x16x32_bf16 v[52:55], v[148:151], v[84:87], v[52:55]
    ds_read_b64_tr_b16 v[170:171], v204 offset:12800
    v_mfma_f32_16x16x32_bf16 v[48:51], v[144:147], v[84:87], v[48:51]
    ds_read_b128 v[108:111], v201 offset:36864
    s_waitcnt lgkmcnt(13)
    v_mfma_f32_16x16x32_bf16 v[48:51], v[152:155], v[88:91], v[48:51]
    buffer_load_dwordx4 v15, s[36:39], s77 offen offset:1024  lds
    v_mfma_f32_16x16x32_bf16 v[52:55], v[156:159], v[88:91], v[52:55]
    ds_read_b64_tr_b16 v[176:177], v204 offset:20480
    v_mfma_f32_16x16x32_bf16 v[56:59], v[136:139], v[88:91], v[56:59]
    ds_read_b64_tr_b16 v[178:179], v204 offset:20992
    v_mfma_f32_16x16x32_bf16 v[60:63], v[140:143], v[88:91], v[60:63]
    s_add_u32 m0, s80, 4096
    ds_read_b64_tr_b16 v[180:181], v206 offset:20480
    buffer_load_dwordx4 v16, s[36:39], s77 offen offset:0  lds
    s_waitcnt lgkmcnt(15)
    v_mfma_f32_16x16x32_bf16 v[60:63], v[148:151], v[92:95], v[60:63]
    ds_read_b64_tr_b16 v[182:183], v206 offset:20992
    v_mfma_f32_16x16x32_bf16 v[56:59], v[144:147], v[92:95], v[56:59]
    ds_read_b128 v[112:115], v201 offset:38912
    s_waitcnt lgkmcnt(15)
    v_mfma_f32_16x16x32_bf16 v[56:59], v[152:155], v[96:99], v[56:59]
    ds_read_b128 v[116:119], v201 offset:40960
    v_mfma_f32_16x16x32_bf16 v[60:63], v[156:159], v[96:99], v[60:63]
    ds_read_b128 v[120:123], v201 offset:43008
    buffer_load_dwordx4 v17, s[36:39], s77 offen offset:1024  lds
    s_waitcnt lgkmcnt(15)
    v_mfma_f32_16x16x32_bf16 v[32:35], v[160:163], v[100:103], v[32:35]
    ds_read_b128 v[124:127], v201 offset:45056
    s_waitcnt lgkmcnt(14)
    v_mfma_f32_16x16x32_bf16 v[36:39], v[164:167], v[100:103], v[36:39]
    ds_read_b128 v[128:131], v201 offset:47104
    s_waitcnt lgkmcnt(12)
    v_mfma_f32_16x16x32_bf16 v[36:39], v[172:175], v[104:107], v[36:39]
    s_add_u32 m0, s80, 6144
    ds_read_b128 v[132:135], v203 offset:32768
    buffer_load_dwordx4 v18, s[36:39], s77 offen offset:0  lds
    s_waitcnt lgkmcnt(11)
    v_mfma_f32_16x16x32_bf16 v[32:35], v[168:171], v[104:107], v[32:35]
    buffer_load_dwordx4 v19, s[36:39], s77 offen offset:1024  lds
    s_waitcnt lgkmcnt(8)
    v_mfma_f32_16x16x32_bf16 v[32:35], v[176:179], v[108:111], v[32:35]
    s_waitcnt lgkmcnt(6)
    v_mfma_f32_16x16x32_bf16 v[36:39], v[180:183], v[108:111], v[36:39]
    s_waitcnt vmcnt(9)
    s_waitcnt lgkmcnt(0)
    s_barrier
    s_waitcnt vmcnt(8)
    s_mov_b32 s94, 60000
L_ap_7:
    v_cmp_eq_u32 vcc, 1, v208
    s_nop 0
    s_cmp_eq_u64 vcc, -1
    s_cbranch_scc1 L_ad_8
    buffer_load_dword v208, v209, s[52:55], 0 offen sc1
    s_waitcnt vmcnt(0)
    s_sub_u32 s94, s94, 1
    s_cmp_lg_u32 s94, 0
    s_cbranch_scc1 L_ap_7
L_ad_8:
    v_lshrrev_b32 v5, 1, v1
    v_lshlrev_b32 v5, 7, v5
    v_and_b32 v6, 1, v1
    v_lshl_add_u32 v209, v6, 4, v5
    s_mov_b32 s87, 14221312
    v_mfma_f32_16x16x32_bf16 v[40:43], v[160:163], v[108:111], v[40:43]
    ds_read_b64_tr_b16 v[136:137], v204 offset:24576
    s_xor_b32 s78, s14, 6
    s_add_u32 s78, s78, s15
    s_and_b32 s78, s78, 7
    s_lshl_b32 s78, s78, 16
    v_mfma_f32_16x16x32_bf16 v[44:47], v[164:167], v[108:111], v[44:47]
    ds_read_b64_tr_b16 v[138:139], v204 offset:25088
    v_mfma_f32_16x16x32_bf16 v[44:47], v[172:175], v[112:115], v[44:47]
    ds_read_b128 v[64:67], v224 offset:0
    v_mfma_f32_16x16x32_bf16 v[40:43], v[168:171], v[112:115], v[40:43]
    ds_read_b64_tr_b16 v[140:141], v206 offset:24576
    v_mfma_f32_16x16x32_bf16 v[40:43], v[176:179], v[116:119], v[40:43]
    ds_read_b64_tr_b16 v[142:143], v206 offset:25088
    s_add_u32 m0, s81, 0
    v_mfma_f32_16x16x32_bf16 v[44:47], v[180:183], v[116:119], v[44:47]
    buffer_load_dwordx4 v20, s[40:43], s78 offen offset:0  lds
    v_mfma_f32_16x16x32_bf16 v[48:51], v[160:163], v[116:119], v[48:51]
    ds_read_b128 v[68:71], v224 offset:2048
    v_mfma_f32_16x16x32_bf16 v[52:55], v[164:167], v[116:119], v[52:55]
    ds_read_b64_tr_b16 v[148:149], v206 offset:32768
    buffer_load_dwordx4 v21, s[40:43], s78 offen offset:1024  lds
    v_mfma_f32_16x16x32_bf16 v[52:55], v[172:175], v[120:123], v[52:55]
    ds_read_b64_tr_b16 v[150:151], v206 offset:33280
    s_nop 0
    s_nop 0
L_PAD1:
    s_cbranch_execz L_PAD5
    v_mfma_f32_16x16x32_bf16 v[48:51], v[168:171], v[120:123], v[48:51]
    s_add_u32 m0, s81, 8192
    ds_read_b64_tr_b16 v[144:145], v204 offset:32768
    buffer_load_dwordx4 v22, s[40:43], s78 offen offset:0  lds
    v_mfma_f32_16x16x32_bf16 v[48:51], v[176:179], v[124:127], v[48:51]
    ds_read_b64_tr_b16 v[146:147], v204 offset:33280
    v_mfma_f32_16x16x32_bf16 v[52:55], v[180:183], v[124:127], v[52:55]
    ds_read_b128 v[72:75], v224 offset:4096
    v_mfma_f32_16x16x32_bf16 v[56:59], v[160:163], v[124:127], v[56:59]
    ds_read_b64_tr_b16 v[152:153], v204 offset:40960
    buffer_load_dwordx4 v23, s[40:43], s78 offen offset:1024  lds
    v_mfma_f32_16x16x32_bf16 v[60:63], v[164:167], v[124:127], v[60:63]
    ds_read_b64_tr_b16 v[154:155], v204 offset:41472
    v_mfma_f32_16x16x32_bf16 v[60:63], v[172:175], v[128:131], v[60:63]
    s_add_u32 m0, s81, 16384
    ds_read_b64_tr_b16 v[156:157], v206 offset:40960
    buffer_load_dwordx4 v24, s[40:43], s78 offen offset:0  lds
    v_mfma_f32_16x16x32_bf16 v[56:59], v[168:171], v[128:131], v[56:59]
    ds_read_b64_tr_b16 v[158:159], v206 offset:41472
    v_mfma_f32_16x16x32_bf16 v[56:59], v[176:179], v[132:135], v[56:59]
    ds_read_b128 v[76:79], v224 offset:6144
    buffer_load_dwordx4 v25, s[40:43], s78 offen offset:1024  lds
    v_mfma_f32_16x16x32_bf16 v[60:63], v[180:183], v[132:135], v[60:63]
    ds_read_b128 v[80:83], v224 offset:8192
    buffer_load_dwordx4 v[244:247], v209, s[44:47], s87 offen sc1
    s_waitcnt lgkmcnt(14)
    v_mfma_f32_16x16x32_bf16 v[32:35], v[136:139], v[64:67], v[32:35]
    ds_read_b128 v[84:87], v224 offset:10240
    s_xor_b32 s77, s14, 7
    s_add_u32 s77, s77, s15
    s_and_b32 s77, s77, 7
    s_lshl_b32 s77, s77, 7
    s_waitcnt lgkmcnt(13)
    v_mfma_f32_16x16x32_bf16 v[36:39], v[140:143], v[64:67], v[36:39]
    ds_read_b128 v[88:91], v224 offset:12288
    s_waitcnt lgkmcnt(11)
    v_mfma_f32_16x16x32_bf16 v[36:39], v[148:151], v[68:71], v[36:39]
    ds_read_b128 v[92:95], v224 offset:14336
    s_waitcnt lgkmcnt(10)
    v_mfma_f32_16x16x32_bf16 v[32:35], v[144:147], v[68:71], v[32:35]
    ds_read_b128 v[96:99], v226 offset:0
    s_waitcnt lgkmcnt(8)
    v_mfma_f32_16x16x32_bf16 v[32:35], v[152:155], v[72:75], v[32:35]
    ds_read_b64_tr_b16 v[160:161], v204 offset:28672
    s_waitcnt lgkmcnt(7)
    v_mfma_f32_16x16x32_bf16 v[36:39], v[156:159], v[72:75], v[36:39]
    ds_read_b64_tr_b16 v[162:163], v204 offset:29184
    s_add_u32 m0, s80, 32768
    v_mfma_f32_16x16x32_bf16 v[40:43], v[136:139], v[72:75], v[40:43]
    buffer_load_dwordx4 v12, s[36:39], s77 offen offset:0  lds
    v_mfma_f32_16x16x32_bf16 v[44:47], v[140:143], v[72:75], v[44:47]
    ds_read_b128 v[100:103], v225 offset:0
    s_waitcnt lgkmcnt(8)
    v_mfma_f32_16x16x32_bf16 v[44:47], v[148:151], v[76:79], v[44:47]
    ds_read_b64_tr_b16 v[164:165], v206 offset:28672
    v_mfma_f32_16x16x32_bf16 v[40:43], v[144:147], v[76:79], v[40:43]
    ds_read_b64_tr_b16 v[166:167], v206 offset:29184
    buffer_load_dwordx4 v13, s[36:39], s77 offen offset:1024  lds
    s_waitcnt lgkmcnt(9)
    v_mfma_f32_16x16x32_bf16 v[40:43], v[152:155], v[80:83], v[40:43]
    ds_read_b128 v[104:107], v225 offset:2048
    v_mfma_f32_16x16x32_bf16 v[44:47], v[156:159], v[80:83], v[44:47]
    ds_read_b64_tr_b16 v[172:173], v206 offset:36864
    v_mfma_f32_16x16x32_bf16 v[48:51], v[136:139], v[80:83], v[48:51]
    ds_read_b64_tr_b16 v[174:175], v206 offset:37376
    v_mfma_f32_16x16x32_bf16 v[52:55], v[140:143], v[80:83], v[52:55]
    s_add_u32 m0, s80, 34816
    ds_read_b64_tr_b16 v[168:169], v204 offset:36864
    buffer_load_dwordx4 v14, s[36:39], s77 offen offset:0  lds
    s_waitcnt lgkmcnt(12)
    v_mfma_f32_16x16x32_bf16 v[52:55], v[148:151], v[84:87], v[52:55]
    ds_read_b64_tr_b16 v[170:171], v204 offset:37376
    v_mfma_f32_16x16x32_bf16 v[48:51], v[144:147], v[84:87], v[48:51]
    ds_read_b128 v[108:111], v225 offset:4096
    s_waitcnt lgkmcnt(13)
    v_mfma_f32_16x16x32_bf16 v[48:51], v[152:155], v[88:91], v[48:51]
    buffer_load_dwordx4 v15, s[36:39], s77 offen offset:1024  lds
    v_mfma_f32_16x16x32_bf16 v[52:55], v[156:159], v[88:91], v[52:55]
    ds_read_b64_tr_b16 v[176:177], v204 offset:45056
    v_mfma_f32_16x16x32_bf16 v[56:59], v[136:139], v[88:91], v[56:59]
    ds_read_b64_tr_b16 v[178:179], v204 offset:45568
    v_mfma_f32_16x16x32_bf16 v[60:63], v[140:143], v[88:91], v[60:63]
    s_add_u32 m0, s80, 36864
    ds_read_b64_tr_b16 v[180:181], v206 offset:45056
    buffer_load_dwordx4 v16, s[36:39], s77 offen offset:0  lds
    s_waitcnt lgkmcnt(15)
    v_mfma_f32_16x16x32_bf16 v[60:63], v[148:151], v[92:95], v[60:63]
    ds_read_b64_tr_b16 v[182:183], v206 offset:45568
    v_mfma_f32_16x16x32_bf16 v[56:59], v[144:147], v[92:95], v[56:59]
    ds_read_b128 v[112:115], v225 offset:6144
    s_waitcnt lgkmcnt(15)
    v_mfma_f32_16x16x32_bf16 v[56:59], v[152:155], v[96:99], v[56:59]
    ds_read_b128 v[116:119], v225 offset:8192
    v_mfma_f32_16x16x32_bf16 v[60:63], v[156:159], v[96:99], v[60:63]
    ds_read_b128 v[120:123], v225 offset:10240
    buffer_load_dwordx4 v17, s[36:39], s77 offen offset:1024  lds
    s_waitcnt lgkmcnt(15)
    v_mfma_f32_16x16x32_bf16 v[32:35], v[160:163], v[100:103], v[32:35]
    ds_read_b128 v[124:127], v225 offset:12288
    s_waitcnt lgkmcnt(14)
    v_mfma_f32_16x16x32_bf16 v[36:39], v[164:167], v[100:103], v[36:39]
    ds_read_b128 v[128:131], v225 offset:14336
    s_waitcnt lgkmcnt(12)
    v_mfma_f32_16x16x32_bf16 v[36:39], v[172:175], v[104:107], v[36:39]
    s_add_u32 m0, s80, 38912
    ds_read_b128 v[132:135], v227 offset:0
    buffer_load_dwordx4 v18, s[36:39], s77 offen offset:0  lds
    s_waitcnt lgkmcnt(11)
    v_mfma_f32_16x16x32_bf16 v[32:35], v[168:171], v[104:107], v[32:35]
    buffer_load_dwordx4 v19, s[36:39], s77 offen offset:1024  lds
    s_waitcnt lgkmcnt(8)
    v_mfma_f32_16x16x32_bf16 v[32:35], v[176:179], v[108:111], v[32:35]
    s_waitcnt lgkmcnt(6)
    v_mfma_f32_16x16x32_bf16 v[36:39], v[180:183], v[108:111], v[36:39]
    s_waitcnt vmcnt(9)
    s_waitcnt lgkmcnt(0)
    s_barrier
    s_waitcnt vmcnt(8)
    s_mov_b32 s94, 60000
L_rp_9:
    v_min_u32 v5, v244, v245
    v_min3_u32 v5, v5, v246, v247
    v_cmp_ne_u32 vcc, 0, v5
    s_nop 0
    s_cmp_eq_u64 vcc, -1
    s_cbranch_scc1 L_rd_10
    buffer_load_dwordx4 v[244:247], v209, s[44:47], s87 offen sc1
    s_waitcnt vmcnt(0)
    s_sub_u32 s94, s94, 1
    s_cmp_lg_u32 s94, 0
    s_cbranch_scc1 L_rp_9
L_rd_10:
    v_and_b32 v244, 15, v244
    v_and_b32 v245, 15, v245
    v_and_b32 v246, 15, v246
    v_and_b32 v247, 15, v247
    v_min_u32 v5, v244, v245
    v_min3_u32 v5, v5, v246, v247
    v_max_u32 v6, v244, v245
    v_max3_u32 v6, v6, v246, v247
    v_cmp_eq_u32 vcc, s18, v5
    v_cmp_eq_u32 s[12:13], s18, v6
    s_nop 0
    s_and_b64 s[12:13], s[12:13], vcc
    s_lshl_b32 s82, s73, 1
    s_lshr_b64 s[12:13], s[12:13], s82
    s_and_b32 s82, s12, 3
    s_cmp_eq_u32 s82, 3
    s_cselect_b32 s17, 1, 0
    s_add_u32 s21, s17, 1
    s_cmp_eq_u32 s72, 0
    s_cselect_b32 s21, s21, 0
    v_mfma_f32_16x16x32_bf16 v[40:43], v[160:163], v[108:111], v[40:43]
    ds_read_b64_tr_b16 v[136:137], v204 offset:0
    s_xor_b32 s78, s14, 7
    s_add_u32 s78, s78, s15
    s_and_b32 s78, s78, 7
    s_lshl_b32 s78, s78, 16
    v_mfma_f32_16x16x32_bf16 v[44:47], v[164:167], v[108:111], v[44:47]
    ds_read_b64_tr_b16 v[138:139], v204 offset:512
    v_mfma_f32_16x16x32_bf16 v[44:47], v[172:175], v[112:115], v[44:47]
    ds_read_b128 v[64:67], v200 offset:0
    v_mfma_f32_16x16x32_bf16 v[40:43], v[168:171], v[112:115], v[40:43]
    ds_read_b64_tr_b16 v[140:141], v206 offset:0
    v_mfma_f32_16x16x32_bf16 v[40:43], v[176:179], v[116:119], v[40:43]
    ds_read_b64_tr_b16 v[142:143], v206 offset:512
    s_add_u32 m0, s81, 24576
    v_mfma_f32_16x16x32_bf16 v[44:47], v[180:183], v[116:119], v[44:47]
    buffer_load_dwordx4 v20, s[40:43], s78 offen offset:0  lds
    v_mfma_f32_16x16x32_bf16 v[48:51], v[160:163], v[116:119], v[48:51]
    ds_read_b128 v[68:71], v200 offset:2048
    v_mfma_f32_16x16x32_bf16 v[52:55], v[164:167], v[116:119], v[52:55]
    ds_read_b64_tr_b16 v[148:149], v206 offset:8192
    v_mfma_f32_16x16x32_bf16 v[52:55], v[172:175], v[120:123], v[52:55]
    ds_read_b64_tr_b16 v[150:151], v206 offset:8704
    buffer_load_dwordx4 v21, s[40:43], s78 offen offset:1024  lds
    v_mfma_f32_16x16x32_bf16 v[48:51], v[168:171], v[120:123], v[48:51]
    ds_read_b64_tr_b16 v[144:145], v204 offset:8192
    v_mfma_f32_16x16x32_bf16 v[48:51], v[176:179], v[124:127], v[48:51]
    s_add_u32 m0, s81, 32768
    ds_read_b64_tr_b16 v[146:147], v204 offset:8704
    buffer_load_dwordx4 v22, s[40:43], s78 offen offset:0  lds
    v_mfma_f32_16x16x32_bf16 v[52:55], v[180:183], v[124:127], v[52:55]
    ds_read_b128 v[72:75], v200 offset:4096
    v_mfma_f32_16x16x32_bf16 v[56:59], v[160:163], v[124:127], v[56:59]
    ds_read_b64_tr_b16 v[152:153], v204 offset:16384
    v_mfma_f32_16x16x32_bf16 v[60:63], v[164:167], v[124:127], v[60:63]
    ds_read_b64_tr_b16 v[154:155], v204 offset:16896
    buffer_load_dwordx4 v23, s[40:43], s78 offen offset:1024  lds
    v_mfma_f32_16x16x32_bf16 v[60:63], v[172:175], v[128:131], v[60:63]
    ds_read_b64_tr_b16 v[156:157], v206 offset:16384
    v_mfma_f32_16x16x32_bf16 v[56:59], v[168:171], v[128:131], v[56:59]
    s_add_u32 m0, s81, 40960
    ds_read_b64_tr_b16 v[158:159], v206 offset:16896
    buffer_load_dwordx4 v24, s[40:43], s78 offen offset:0  lds
    v_mfma_f32_16x16x32_bf16 v[56:59], v[176:179], v[132:135], v[56:59]
    ds_read_b128 v[76:79], v200 offset:6144
    v_mfma_f32_16x16x32_bf16 v[60:63], v[180:183], v[132:135], v[60:63]
    ds_read_b128 v[80:83], v200 offset:8192
    buffer_load_dwordx4 v25, s[40:43], s78 offen offset:1024  lds
    s_waitcnt lgkmcnt(14)
    v_mfma_f32_16x16x32_bf16 v[32:35], v[136:139], v[64:67], v[32:35]
    ds_read_b128 v[84:87], v200 offset:10240
    s_waitcnt lgkmcnt(13)
    v_mfma_f32_16x16x32_bf16 v[36:39], v[140:143], v[64:67], v[36:39]
    ds_read_b128 v[88:91], v200 offset:12288
    s_waitcnt lgkmcnt(11)
    v_mfma_f32_16x16x32_bf16 v[36:39], v[148:151], v[68:71], v[36:39]
    ds_read_b128 v[92:95], v200 offset:14336
    s_waitcnt lgkmcnt(10)
    v_mfma_f32_16x16x32_bf16 v[32:35], v[144:147], v[68:71], v[32:35]
    s_lshr_b32 s85, s2, 3
    s_lshl_b32 s85, s85, 2
    s_add_u32 s85, s85, s72
    s_lshl_b32 s85, s85, 12
    s_add_u32 s85, s85, 2097152
    buffer_load_dwordx4 v[228:231], v2, s[44:47], s85 offen offset:0 sc1
    s_waitcnt lgkmcnt(7)
    v_mfma_f32_16x16x32_bf16 v[32:35], v[152:155], v[72:75], v[32:35]
    ds_read_b128 v[96:99], v202 offset:0
    s_waitcnt lgkmcnt(6)
    v_mfma_f32_16x16x32_bf16 v[36:39], v[156:159], v[72:75], v[36:39]
    ds_read_b64_tr_b16 v[160:161], v204 offset:4096
    v_mfma_f32_16x16x32_bf16 v[40:43], v[136:139], v[72:75], v[40:43]
    ds_read_b64_tr_b16 v[162:163], v204 offset:4608
    v_mfma_f32_16x16x32_bf16 v[44:47], v[140:143], v[72:75], v[44:47]
    ds_read_b128 v[100:103], v201 offset:0
    buffer_load_dwordx4 v[232:235], v2, s[44:47], s85 offen offset:1024 sc1
    s_waitcnt lgkmcnt(8)
    v_mfma_f32_16x16x32_bf16 v[44:47], v[148:151], v[76:79], v[44:47]
    ds_read_b64_tr_b16 v[164:165], v206 offset:4096
    v_mfma_f32_16x16x32_bf16 v[40:43], v[144:147], v[76:79], v[40:43]
    ds_read_b64_tr_b16 v[166:167], v206 offset:4608
    s_waitcnt lgkmcnt(9)
    v_mfma_f32_16x16x32_bf16 v[40:43], v[152:155], v[80:83], v[40:43]
    ds_read_b128 v[104:107], v201 offset:2048
    v_mfma_f32_16x16x32_bf16 v[44:47], v[156:159], v[80:83], v[44:47]
    ds_read_b64_tr_b16 v[172:173], v206 offset:12288
    buffer_load_dwordx4 v[236:239], v2, s[44:47], s85 offen offset:2048 sc1
    v_mfma_f32_16x16x32_bf16 v[48:51], v[136:139], v[80:83], v[48:51]
    ds_read_b64_tr_b16 v[174:175], v206 offset:12800
    v_mfma_f32_16x16x32_bf16 v[52:55], v[140:143], v[80:83], v[52:55]
    ds_read_b64_tr_b16 v[168:169], v204 offset:12288
    s_waitcnt lgkmcnt(12)
    v_mfma_f32_16x16x32_bf16 v[52:55], v[148:151], v[84:87], v[52:55]
    ds_read_b64_tr_b16 v[170:171], v204 offset:12800
    v_mfma_f32_16x16x32_bf16 v[48:51], v[144:147], v[84:87], v[48:51]
    buffer_load_dwordx4 v[240:243], v2, s[44:47], s85 offen offset:3072 sc1
    s_waitcnt lgkmcnt(12)
    v_mfma_f32_16x16x32_bf16 v[48:51], v[152:155], v[88:91], v[48:51]
    ds_read_b128 v[108:111], v201 offset:4096
    v_mfma_f32_16x16x32_bf16 v[52:55], v[156:159], v[88:91], v[52:55]
    ds_read_b64_tr_b16 v[176:177], v204 offset:20480
    v_mfma_f32_16x16x32_bf16 v[56:59], v[136:139], v[88:91], v[56:59]
    ds_read_b64_tr_b16 v[178:179], v204 offset:20992
    v_mfma_f32_16x16x32_bf16 v[60:63], v[140:143], v[88:91], v[60:63]
    ds_read_b64_tr_b16 v[180:181], v206 offset:20480
    s_lshl_b32 s7, s74, 2
    s_add_u32 s7, s7, s72
    s_mul_i32 s7, s7, 49152
    s_mul_i32 s3, s79, 3072
    s_add_u32 s3, s3, s7
    buffer_load_dwordx4 a[0:3], v2, s[44:47], s3 offen offset:0 sc1
    s_waitcnt lgkmcnt(15)
    v_mfma_f32_16x16x32_bf16 v[60:63], v[148:151], v[92:95], v[60:63]
    ds_read_b64_tr_b16 v[182:183], v206 offset:20992
    v_mfma_f32_16x16x32_bf16 v[56:59], v[144:147], v[92:95], v[56:59]
    ds_read_b128 v[112:115], v201 offset:6144
    s_waitcnt lgkmcnt(15)
    v_mfma_f32_16x16x32_bf16 v[56:59], v[152:155], v[96:99], v[56:59]
    ds_read_b128 v[116:119], v201 offset:8192
    v_mfma_f32_16x16x32_bf16 v[60:63], v[156:159], v[96:99], v[60:63]
    ds_read_b128 v[120:123], v201 offset:10240
    buffer_load_dwordx4 a[4:7], v2, s[44:47], s3 offen offset:1024 sc1
    s_waitcnt lgkmcnt(15)
    v_mfma_f32_16x16x32_bf16 v[32:35], v[160:163], v[100:103], v[32:35]
    ds_read_b128 v[124:127], v201 offset:12288
    s_waitcnt lgkmcnt(14)
    v_mfma_f32_16x16x32_bf16 v[36:39], v[164:167], v[100:103], v[36:39]
    ds_read_b128 v[128:131], v201 offset:14336
    s_waitcnt lgkmcnt(12)
    v_mfma_f32_16x16x32_bf16 v[36:39], v[172:175], v[104:107], v[36:39]
    ds_read_b128 v[132:135], v203 offset:0
    s_waitcnt lgkmcnt(11)
    v_mfma_f32_16x16x32_bf16 v[32:35], v[168:171], v[104:107], v[32:35]
    buffer_load_dwordx4 a[8:11], v2, s[44:47], s3 offen offset:2048 sc1
    s_waitcnt lgkmcnt(8)
    v_mfma_f32_16x16x32_bf16 v[32:35], v[176:179], v[108:111], v[32:35]
    s_add_u32 s79, s79, 1
    s_and_b32 s79, s79, 15
    s_mul_i32 s3, s79, 3072
    s_add_u32 s3, s3, s7
    buffer_load_dwordx4 a[12:15], v2, s[44:47], s3 offen offset:0 sc1
    s_waitcnt lgkmcnt(6)
    v_mfma_f32_16x16x32_bf16 v[36:39], v[180:183], v[108:111], v[36:39]
    v_mfma_f32_16x16x32_bf16 v[40:43], v[160:163], v[108:111], v[40:43]
    v_mfma_f32_16x16x32_bf16 v[44:47], v[164:167], v[108:111], v[44:47]
    s_waitcnt lgkmcnt(5)
    v_mfma_f32_16x16x32_bf16 v[44:47], v[172:175], v[112:115], v[44:47]
    buffer_load_dwordx4 a[16:19], v2, s[44:47], s3 offen offset:1024 sc1
    v_mfma_f32_16x16x32_bf16 v[40:43], v[168:171], v[112:115], v[40:43]
    s_waitcnt lgkmcnt(4)
    v_mfma_f32_16x16x32_bf16 v[40:43], v[176:179], v[116:119], v[40:43]
    v_mfma_f32_16x16x32_bf16 v[44:47], v[180:183], v[116:119], v[44:47]
    v_mfma_f32_16x16x32_bf16 v[48:51], v[160:163], v[116:119], v[48:51]
    buffer_load_dwordx4 a[20:23], v2, s[44:47], s3 offen offset:2048 sc1
    v_mfma_f32_16x16x32_bf16 v[52:55], v[164:167], v[116:119], v[52:55]
    s_waitcnt lgkmcnt(3)
    v_mfma_f32_16x16x32_bf16 v[52:55], v[172:175], v[120:123], v[52:55]
    v_mfma_f32_16x16x32_bf16 v[48:51], v[168:171], v[120:123], v[48:51]
    s_waitcnt lgkmcnt(2)
    v_mfma_f32_16x16x32_bf16 v[48:51], v[176:179], v[124:127], v[48:51]
    s_add_u32 s79, s79, 1
    s_and_b32 s79, s79, 15
    s_mul_i32 s3, s79, 3072
    s_add_u32 s3, s3, s7
    buffer_load_dwordx4 a[24:27], v2, s[44:47], s3 offen offset:0 sc1
    v_mfma_f32_16x16x32_bf16 v[52:55], v[180:183], v[124:127], v[52:55]
    v_mfma_f32_16x16x32_bf16 v[56:59], v[160:163], v[124:127], v[56:59]
    v_mfma_f32_16x16x32_bf16 v[60:63], v[164:167], v[124:127], v[60:63]
    s_waitcnt lgkmcnt(1)
    v_mfma_f32_16x16x32_bf16 v[60:63], v[172:175], v[128:131], v[60:63]
    buffer_load_dwordx4 a[28:31], v2, s[44:47], s3 offen offset:1024 sc1
    v_mfma_f32_16x16x32_bf16 v[56:59], v[168:171], v[128:131], v[56:59]
    s_waitcnt lgkmcnt(0)
    v_mfma_f32_16x16x32_bf16 v[56:59], v[176:179], v[132:135], v[56:59]
    v_mfma_f32_16x16x32_bf16 v[60:63], v[180:183], v[132:135], v[60:63]
    s_waitcnt vmcnt(12)
    s_waitcnt lgkmcnt(0)
    s_barrier
    s_lshl_b32 s82, s73, 17
    s_lshl_b32 s83, s74, 14
    s_add_u32 s82, s82, s83
    s_lshl_b32 s83, s98, 13
    s_add_u32 s82, s82, s83
    s_lshl_b32 s83, s99, 12
    s_add_u32 s82, s82, s83
    s_add_u32 s8, s82, 3145728
    s_lshl_b32 s82, s98, 13
    s_lshl_b32 s83, s99, 12
    s_add_u32 s82, s82, s83
    v_add_u32 v210, s82, v2
    ds_read_b64_tr_b16 v[136:137], v204 offset:24576
    ds_read_b64_tr_b16 v[138:139], v204 offset:25088
    ds_read_b128 v[64:67], v200 offset:32768
    ds_read_b64_tr_b16 v[140:141], v206 offset:24576
    ds_read_b64_tr_b16 v[142:143], v206 offset:25088
    ds_read_b128 v[68:71], v200 offset:34816
    ds_read_b64_tr_b16 v[148:149], v206 offset:32768
    ds_read_b64_tr_b16 v[150:151], v206 offset:33280
    ds_read_b64_tr_b16 v[144:145], v204 offset:32768
    ds_read_b64_tr_b16 v[146:147], v204 offset:33280
    s_waitcnt lgkmcnt(7)
    v_mfma_f32_16x16x32_bf16 v[32:35], v[136:139], v[64:67], v[32:35]
    ds_read_b128 v[72:75], v200 offset:36864
    s_waitcnt lgkmcnt(6)
    v_mfma_f32_16x16x32_bf16 v[36:39], v[140:143], v[64:67], v[36:39]
    ds_read_b64_tr_b16 v[152:153], v204 offset:40960
    s_waitcnt lgkmcnt(4)
    v_mfma_f32_16x16x32_bf16 v[36:39], v[148:151], v[68:71], v[36:39]
    ds_read_b64_tr_b16 v[154:155], v204 offset:41472
    s_waitcnt lgkmcnt(3)
    v_mfma_f32_16x16x32_bf16 v[32:35], v[144:147], v[68:71], v[32:35]
    ds_read_b64_tr_b16 v[156:157], v206 offset:40960
    s_waitcnt lgkmcnt(1)
    v_mfma_f32_16x16x32_bf16 v[32:35], v[152:155], v[72:75], v[32:35]
    ds_read_b64_tr_b16 v[158:159], v206 offset:41472
    s_waitcnt lgkmcnt(0)
    v_mfma_f32_16x16x32_bf16 v[36:39], v[156:159], v[72:75], v[36:39]
    ds_read_b128 v[76:79], v200 offset:38912
    v_mfma_f32_16x16x32_bf16 v[40:43], v[136:139], v[72:75], v[40:43]
    ds_read_b128 v[80:83], v200 offset:40960
    v_mfma_f32_16x16x32_bf16 v[44:47], v[140:143], v[72:75], v[44:47]
    ds_read_b128 v[84:87], v200 offset:43008
    s_waitcnt lgkmcnt(2)
    v_mfma_f32_16x16x32_bf16 v[44:47], v[148:151], v[76:79], v[44:47]
    ds_read_b128 v[88:91], v200 offset:45056
    v_mfma_f32_16x16x32_bf16 v[40:43], v[144:147], v[76:79], v[40:43]
    ds_read_b128 v[92:95], v200 offset:47104
    s_waitcnt lgkmcnt(3)
    v_mfma_f32_16x16x32_bf16 v[40:43], v[152:155], v[80:83], v[40:43]
    ds_read_b128 v[96:99], v202 offset:32768
    v_mfma_f32_16x16x32_bf16 v[44:47], v[156:159], v[80:83], v[44:47]
    ds_read_b64_tr_b16 v[160:161], v204 offset:28672
    buffer_load_dwordx4 a[32:35], v2, s[44:47], s3 offen offset:2048 sc1
    v_mfma_f32_16x16x32_bf16 v[48:51], v[136:139], v[80:83], v[48:51]
    ds_read_b64_tr_b16 v[162:163], v204 offset:29184
    v_mfma_f32_16x16x32_bf16 v[52:55], v[140:143], v[80:83], v[52:55]
    ds_read_b128 v[100:103], v201 offset:32768
    s_waitcnt lgkmcnt(6)
    v_mfma_f32_16x16x32_bf16 v[52:55], v[148:151], v[84:87], v[52:55]
    ds_read_b64_tr_b16 v[164:165], v206 offset:28672
    v_mfma_f32_16x16x32_bf16 v[48:51], v[144:147], v[84:87], v[48:51]
    ds_read_b64_tr_b16 v[166:167], v206 offset:29184
    s_waitcnt lgkmcnt(7)
    v_mfma_f32_16x16x32_bf16 v[48:51], v[152:155], v[88:91], v[48:51]
    ds_read_b128 v[104:107], v201 offset:34816
    ds_read_b64_tr_b16 v[172:173], v206 offset:36864
    s_add_u32 s79, s79, 1
    s_and_b32 s79, s79, 15
    s_mul_i32 s3, s79, 3072
    s_add_u32 s3, s3, s7
    buffer_load_dwordx4 a[36:39], v2, s[44:47], s3 offen offset:0 sc1
    v_mfma_f32_16x16x32_bf16 v[52:55], v[156:159], v[88:91], v[52:55]
    ds_read_b64_tr_b16 v[174:175], v206 offset:37376
    v_mfma_f32_16x16x32_bf16 v[56:59], v[136:139], v[88:91], v[56:59]
    ds_read_b64_tr_b16 v[168:169], v204 offset:36864
    v_mfma_f32_16x16x32_bf16 v[60:63], v[140:143], v[88:91], v[60:63]
    ds_read_b64_tr_b16 v[170:171], v204 offset:37376
    s_waitcnt lgkmcnt(11)
    v_mfma_f32_16x16x32_bf16 v[60:63], v[148:151], v[92:95], v[60:63]
    ds_read_b128 v[108:111], v201 offset:36864
    v_mfma_f32_16x16x32_bf16 v[56:59], v[144:147], v[92:95], v[56:59]
    ds_read_b64_tr_b16 v[176:177], v204 offset:45056
    s_waitcnt lgkmcnt(12)
    v_mfma_f32_16x16x32_bf16 v[56:59], v[152:155], v[96:99], v[56:59]
    ds_read_b64_tr_b16 v[178:179], v204 offset:45568
    buffer_load_dwordx4 a[40:43], v2, s[44:47], s3 offen offset:1024 sc1
    v_mfma_f32_16x16x32_bf16 v[60:63], v[156:159], v[96:99], v[60:63]
    ds_read_b64_tr_b16 v[180:181], v206 offset:45056
    s_waitcnt lgkmcnt(11)
    v_mfma_f32_16x16x32_bf16 v[32:35], v[160:163], v[100:103], v[32:35]
    ds_read_b64_tr_b16 v[182:183], v206 offset:45568
    s_waitcnt lgkmcnt(10)
    v_mfma_f32_16x16x32_bf16 v[36:39], v[164:167], v[100:103], v[36:39]
    ds_read_b128 v[112:115], v201 offset:38912
    s_waitcnt lgkmcnt(8)
    v_mfma_f32_16x16x32_bf16 v[36:39], v[172:175], v[104:107], v[36:39]
    ds_read_b128 v[116:119], v201 offset:40960
    s_waitcnt lgkmcnt(7)
    v_mfma_f32_16x16x32_bf16 v[32:35], v[168:171], v[104:107], v[32:35]
    ds_read_b128 v[120:123], v201 offset:43008
    s_waitcnt lgkmcnt(5)
    v_mfma_f32_16x16x32_bf16 v[32:35], v[176:179], v[108:111], v[32:35]
    ds_read_b128 v[124:127], v201 offset:45056
    buffer_load_dwordx4 a[44:47], v2, s[44:47], s3 offen offset:2048 sc1
    s_waitcnt lgkmcnt(4)
    v_mfma_f32_16x16x32_bf16 v[36:39], v[180:183], v[108:111], v[36:39]
    ds_read_b128 v[128:131], v201 offset:47104
    ds_read_b128 v[132:135], v203 offset:32768
    v_mfma_f32_16x16x32_bf16 v[40:43], v[160:163], v[108:111], v[40:43]
    s_add_u32 s79, s79, 1
    s_and_b32 s79, s79, 15
    s_mul_i32 s3, s79, 3072
    s_add_u32 s3, s3, s7
    buffer_load_dwordx4 a[48:51], v2, s[44:47], s3 offen offset:0 sc1
    v_mfma_f32_16x16x32_bf16 v[44:47], v[164:167], v[108:111], v[44:47]
    s_waitcnt lgkmcnt(5)
    v_mfma_f32_16x16x32_bf16 v[44:47], v[172:175], v[112:115], v[44:47]
    v_mfma_f32_16x16x32_bf16 v[40:43], v[168:171], v[112:115], v[40:43]
    s_waitcnt lgkmcnt(4)
    v_mfma_f32_16x16x32_bf16 v[40:43], v[176:179], v[116:119], v[40:43]
    v_mfma_f32_16x16x32_bf16 v[44:47], v[180:183], v[116:119], v[44:47]
    v_mfma_f32_16x16x32_bf16 v[48:51], v[160:163], v[116:119], v[48:51]
    buffer_load_dwordx4 a[52:55], v2, s[44:47], s3 offen offset:1024 sc1
    v_mfma_f32_16x16x32_bf16 v[52:55], v[164:167], v[116:119], v[52:55]
    s_waitcnt lgkmcnt(3)
    v_mfma_f32_16x16x32_bf16 v[52:55], v[172:175], v[120:123], v[52:55]
    v_mfma_f32_16x16x32_bf16 v[48:51], v[168:171], v[120:123], v[48:51]
    s_waitcnt lgkmcnt(2)
    v_mfma_f32_16x16x32_bf16 v[48:51], v[176:179], v[124:127], v[48:51]
    v_mfma_f32_16x16x32_bf16 v[52:55], v[180:183], v[124:127], v[52:55]
    v_mfma_f32_16x16x32_bf16 v[56:59], v[160:163], v[124:127], v[56:59]
    buffer_load_dwordx4 a[56:59], v2, s[44:47], s3 offen offset:2048 sc1
    v_mfma_f32_16x16x32_bf16 v[60:63], v[164:167], v[124:127], v[60:63]
    s_waitcnt lgkmcnt(1)
    v_mfma_f32_16x16x32_bf16 v[60:63], v[172:175], v[128:131], v[60:63]
    v_mfma_f32_16x16x32_bf16 v[56:59], v[168:171], v[128:131], v[56:59]
    s_waitcnt lgkmcnt(0)
    v_mfma_f32_16x16x32_bf16 v[56:59], v[176:179], v[132:135], v[56:59]
    v_mfma_f32_16x16x32_bf16 v[60:63], v[180:183], v[132:135], v[60:63]
    v_pk_mul_f32 v[184:185], v[32:33], v[32:33]
    s_add_u32 s79, s79, 1
    s_and_b32 s79, s79, 15
    s_mul_i32 s3, s79, 3072
    s_add_u32 s3, s3, s7
    buffer_load_dwordx4 a[60:63], v2, s[44:47], s3 offen offset:0 sc1
    v_pk_mul_f32 v[186:187], v[34:35], v[34:35]
    v_pk_mul_f32 v[188:189], v[36:37], v[36:37]
    v_pk_mul_f32 v[190:191], v[38:39], v[38:39]
    v_pk_fma_f32 v[184:185], v[184:185], v[10:11], v[10:11] op_sel:[0,0,1] op_sel_hi:[1,0,1]
    v_pk_fma_f32 v[186:187], v[186:187], v[10:11], v[10:11] op_sel:[0,0,1] op_sel_hi:[1,0,1]
    v_pk_fma_f32 v[188:189], v[188:189], v[10:11], v[10:11] op_sel:[0,0,1] op_sel_hi:[1,0,1]
    v_pk_fma_f32 v[190:191], v[190:191], v[10:11], v[10:11] op_sel:[0,0,1] op_sel_hi:[1,0,1]
    v_pk_mul_f32 v[184:185], v[184:185], v[32:33]
    v_pk_mul_f32 v[186:187], v[186:187], v[34:35]
    v_pk_mul_f32 v[188:189], v[188:189], v[36:37]
    v_pk_mul_f32 v[190:191], v[190:191], v[38:39]
    v_exp_f32 v184, v184
    v_exp_f32 v185, v185
    v_exp_f32 v186, v186
    v_exp_f32 v187, v187
    v_exp_f32 v188, v188
    v_exp_f32 v189, v189
    v_exp_f32 v190, v190
    buffer_load_dwordx4 a[64:67], v2, s[44:47], s3 offen offset:1024 sc1
    v_exp_f32 v191, v191
    v_pk_add_f32 v[184:185], v[184:185], 1.0 op_sel_hi:[1,0]
    v_pk_add_f32 v[186:187], v[186:187], 1.0 op_sel_hi:[1,0]
    v_pk_add_f32 v[188:189], v[188:189], 1.0 op_sel_hi:[1,0]
    v_pk_add_f32 v[190:191], v[190:191], 1.0 op_sel_hi:[1,0]
    v_rcp_f32 v184, v184
    v_rcp_f32 v185, v185
    v_rcp_f32 v186, v186
    v_rcp_f32 v187, v187
    v_rcp_f32 v188, v188
    v_rcp_f32 v189, v189
    v_rcp_f32 v190, v190
    v_rcp_f32 v191, v191
    v_pk_mul_f32 v[32:33], v[32:33], v[184:185]
    v_pk_mul_f32 v[34:35], v[34:35], v[186:187]
    v_pk_mul_f32 v[36:37], v[36:37], v[188:189]
    v_pk_mul_f32 v[38:39], v[38:39], v[190:191]
    v_cvt_pk_bf16_f32 v136, v32, v33
    v_cvt_pk_bf16_f32 v137, v34, v35
    buffer_load_dwordx4 a[68:71], v2, s[44:47], s3 offen offset:2048 sc1
    v_cvt_pk_bf16_f32 v138, v36, v37
    v_cvt_pk_bf16_f32 v139, v38, v39
    buffer_store_dwordx4 v[136:139], v2, s[44:47], s8 offen offset:0 sc1
    v_pk_mul_f32 v[192:193], v[40:41], v[40:41]
    v_pk_mul_f32 v[194:195], v[42:43], v[42:43]
    v_pk_mul_f32 v[196:197], v[44:45], v[44:45]
    v_pk_mul_f32 v[198:199], v[46:47], v[46:47]
    v_pk_fma_f32 v[192:193], v[192:193], v[10:11], v[10:11] op_sel:[0,0,1] op_sel_hi:[1,0,1]
    v_pk_fma_f32 v[194:195], v[194:195], v[10:11], v[10:11] op_sel:[0,0,1] op_sel_hi:[1,0,1]
    v_pk_fma_f32 v[196:197], v[196:197], v[10:11], v[10:11] op_sel:[0,0,1] op_sel_hi:[1,0,1]
    v_pk_fma_f32 v[198:199], v[198:199], v[10:11], v[10:11] op_sel:[0,0,1] op_sel_hi:[1,0,1]
    v_pk_mul_f32 v[192:193], v[192:193], v[40:41]
    v_pk_mul_f32 v[194:195], v[194:195], v[42:43]
    v_pk_mul_f32 v[196:197], v[196:197], v[44:45]
    v_pk_mul_f32 v[198:199], v[198:199], v[46:47]
    v_exp_f32 v192, v192
    v_exp_f32 v193, v193
    v_exp_f32 v194, v194
    s_add_u32 s79, s79, 1
    s_and_b32 s79, s79, 15
    s_mul_i32 s3, s79, 3072
    s_add_u32 s3, s3, s7
    buffer_load_dwordx4 a[72:75], v2, s[44:47], s3 offen offset:0 sc1
    v_exp_f32 v195, v195
    v_exp_f32 v196, v196
    v_exp_f32 v197, v197
    v_exp_f32 v198, v198
    v_exp_f32 v199, v199
    v_pk_add_f32 v[192:193], v[192:193], 1.0 op_sel_hi:[1,0]
    v_pk_add_f32 v[194:195], v[194:195], 1.0 op_sel_hi:[1,0]
    v_pk_add_f32 v[196:197], v[196:197], 1.0 op_sel_hi:[1,0]
    v_pk_add_f32 v[198:199], v[198:199], 1.0 op_sel_hi:[1,0]
    v_rcp_f32 v192, v192
    v_rcp_f32 v193, v193
    v_rcp_f32 v194, v194
    v_rcp_f32 v195, v195
    v_rcp_f32 v196, v196
    v_rcp_f32 v197, v197
    v_rcp_f32 v198, v198
    v_rcp_f32 v199, v199
    v_pk_mul_f32 v[40:41], v[40:41], v[192:193]
    v_pk_mul_f32 v[42:43], v[42:43], v[194:195]
    buffer_load_dwordx4 a[76:79], v2, s[44:47], s3 offen offset:1024 sc1
    v_pk_mul_f32 v[44:45], v[44:45], v[196:197]
    v_pk_mul_f32 v[46:47], v[46:47], v[198:199]
    v_cvt_pk_bf16_f32 v140, v40, v41
    v_cvt_pk_bf16_f32 v141, v42, v43
    v_cvt_pk_bf16_f32 v142, v44, v45
    v_cvt_pk_bf16_f32 v143, v46, v47
    buffer_store_dwordx4 v[140:143], v2, s[44:47], s8 offen offset:1024 sc1
    v_pk_mul_f32 v[184:185], v[48:49], v[48:49]
    v_pk_mul_f32 v[186:187], v[50:51], v[50:51]
    v_pk_mul_f32 v[188:189], v[52:53], v[52:53]
    v_pk_mul_f32 v[190:191], v[54:55], v[54:55]
    v_pk_fma_f32 v[184:185], v[184:185], v[10:11], v[10:11] op_sel:[0,0,1] op_sel_hi:[1,0,1]
    v_pk_fma_f32 v[186:187], v[186:187], v[10:11], v[10:11] op_sel:[0,0,1] op_sel_hi:[1,0,1]
    v_pk_fma_f32 v[188:189], v[188:189], v[10:11], v[10:11] op_sel:[0,0,1] op_sel_hi:[1,0,1]
    v_pk_fma_f32 v[190:191], v[190:191], v[10:11], v[10:11] op_sel:[0,0,1] op_sel_hi:[1,0,1]
    v_pk_mul_f32 v[184:185], v[184:185], v[48:49]
    v_pk_mul_f32 v[186:187], v[186:187], v[50:51]
    v_pk_mul_f32 v[188:189], v[188:189], v[52:53]
    buffer_load_dwordx4 a[80:83], v2, s[44:47], s3 offen offset:2048 sc1
    v_pk_mul_f32 v[190:191], v[190:191], v[54:55]
    v_exp_f32 v184, v184
    v_exp_f32 v185, v185
    v_exp_f32 v186, v186
    v_exp_f32 v187, v187
    v_exp_f32 v188, v188
    v_exp_f32 v189, v189
    v_exp_f32 v190, v190
    v_exp_f32 v191, v191
    v_pk_add_f32 v[184:185], v[184:185], 1.0 op_sel_hi:[1,0]
    v_pk_add_f32 v[186:187], v[186:187], 1.0 op_sel_hi:[1,0]
    v_pk_add_f32 v[188:189], v[188:189], 1.0 op_sel_hi:[1,0]
    v_pk_add_f32 v[190:191], v[190:191], 1.0 op_sel_hi:[1,0]
    v_rcp_f32 v184, v184
    v_rcp_f32 v185, v185
    v_rcp_f32 v186, v186
    v_rcp_f32 v187, v187
    v_rcp_f32 v188, v188
    v_rcp_f32 v189, v189
    s_add_u32 s79, s79, 1
    s_and_b32 s79, s79, 15
    s_mul_i32 s3, s79, 3072
    s_add_u32 s3, s3, s7
    buffer_load_dwordx4 a[84:87], v2, s[44:47], s3 offen offset:0 sc1
    v_rcp_f32 v190, v190
    v_rcp_f32 v191, v191
    v_pk_mul_f32 v[48:49], v[48:49], v[184:185]
    v_pk_mul_f32 v[50:51], v[50:51], v[186:187]
    v_pk_mul_f32 v[52:53], v[52:53], v[188:189]
    v_pk_mul_f32 v[54:55], v[54:55], v[190:191]
    v_cvt_pk_bf16_f32 v144, v48, v49
    v_cvt_pk_bf16_f32 v145, v50, v51
    s_nop 0
L_PAD2:
    s_cbranch_execz L_PAD6
    v_cvt_pk_bf16_f32 v146, v52, v53
    v_cvt_pk_bf16_f32 v147, v54, v55
    buffer_store_dwordx4 v[144:147], v2, s[44:47], s8 offen offset:2048 sc1
    v_pk_mul_f32 v[192:193], v[56:57], v[56:57]
    v_pk_mul_f32 v[194:195], v[58:59], v[58:59]
    v_pk_mul_f32 v[196:197], v[60:61], v[60:61]
    v_pk_mul_f32 v[198:199], v[62:63], v[62:63]
    v_pk_fma_f32 v[192:193], v[192:193], v[10:11], v[10:11] op_sel:[0,0,1] op_sel_hi:[1,0,1]
    v_pk_fma_f32 v[194:195], v[194:195], v[10:11], v[10:11] op_sel:[0,0,1] op_sel_hi:[1,0,1]
    v_pk_fma_f32 v[196:197], v[196:197], v[10:11], v[10:11] op_sel:[0,0,1] op_sel_hi:[1,0,1]
    v_pk_fma_f32 v[198:199], v[198:199], v[10:11], v[10:11] op_sel:[0,0,1] op_sel_hi:[1,0,1]
    v_pk_mul_f32 v[192:193], v[192:193], v[56:57]
    v_pk_mul_f32 v[194:195], v[194:195], v[58:59]
    v_pk_mul_f32 v[196:197], v[196:197], v[60:61]
    v_pk_mul_f32 v[198:199], v[198:199], v[62:63]
    v_exp_f32 v192, v192
    v_exp_f32 v193, v193
    v_exp_f32 v194, v194
    v_exp_f32 v195, v195
    v_exp_f32 v196, v196
    v_exp_f32 v197, v197
    v_exp_f32 v198, v198
    v_exp_f32 v199, v199
    v_pk_add_f32 v[192:193], v[192:193], 1.0 op_sel_hi:[1,0]
    v_pk_add_f32 v[194:195], v[194:195], 1.0 op_sel_hi:[1,0]
    v_pk_add_f32 v[196:197], v[196:197], 1.0 op_sel_hi:[1,0]
    v_pk_add_f32 v[198:199], v[198:199], 1.0 op_sel_hi:[1,0]
    v_rcp_f32 v192, v192
    v_rcp_f32 v193, v193
    v_rcp_f32 v194, v194
    v_rcp_f32 v195, v195
    v_rcp_f32 v196, v196
    v_rcp_f32 v197, v197
    v_rcp_f32 v198, v198
    v_rcp_f32 v199, v199
    v_pk_mul_f32 v[56:57], v[56:57], v[192:193]
    v_pk_mul_f32 v[58:59], v[58:59], v[194:195]
    v_pk_mul_f32 v[60:61], v[60:61], v[196:197]
    v_pk_mul_f32 v[62:63], v[62:63], v[198:199]
    v_cvt_pk_bf16_f32 v148, v56, v57
    v_cvt_pk_bf16_f32 v149, v58, v59
    v_cvt_pk_bf16_f32 v150, v60, v61
    v_cvt_pk_bf16_f32 v151, v62, v63
    buffer_store_dwordx4 v[148:151], v2, s[44:47], s8 offen offset:3072 sc1
    ds_write_b128 v210, v[136:139] offset:0
    ds_write_b128 v210, v[140:143] offset:1024
    ds_write_b128 v210, v[144:147] offset:2048
    ds_write_b128 v210, v[148:151] offset:3072
    buffer_load_dwordx4 a[88:91], v2, s[44:47], s3 offen offset:1024 sc1
    buffer_load_dwordx4 a[92:95], v2, s[44:47], s3 offen offset:2048 sc1
    s_add_u32 s79, s79, 1
    s_and_b32 s79, s79, 15
    s_mul_i32 s3, s79, 3072
    s_add_u32 s3, s3, s7
    buffer_load_dwordx4 a[96:99], v2, s[44:47], s3 offen offset:0 sc1
    buffer_load_dwordx4 a[100:103], v2, s[44:47], s3 offen offset:1024 sc1
    v_and_b32 v5, 7, v1
    v_mul_u32_u24 v5, 1056, v5
    v_lshl_add_u32 v5, v4, 4, v5
    s_lshl_b32 s82, s72, 8
    s_add_u32 s82, s82, 147456
    v_add_u32 v5, s82, v5
    ds_read_b128 v[64:67], v5 offset:0
    ds_read_b128 v[68:71], v5 offset:64
    ds_read_b128 v[72:75], v5 offset:128
    ds_read_b128 v[76:79], v5 offset:192
    s_lshl_b32 s82, s72, 10
    s_add_u32 s82, s82, 155904
    v_add_u32 v6, s82, v2
    s_waitcnt vmcnt(33) lgkmcnt(3)
    v_mfma_f32_16x16x32_bf16 v[80:83], v[228:231], v[64:67], 0
    s_waitcnt vmcnt(32) lgkmcnt(2)
    v_mfma_f32_16x16x32_bf16 v[80:83], v[232:235], v[68:71], v[80:83]
    s_waitcnt vmcnt(31) lgkmcnt(1)
    v_mfma_f32_16x16x32_bf16 v[80:83], v[236:239], v[72:75], v[80:83]
    s_waitcnt vmcnt(30) lgkmcnt(0)
    v_mfma_f32_16x16x32_bf16 v[80:83], v[240:243], v[76:79], v[80:83]
    s_nop 7
    ds_write_b128 v6, v[80:83]
    s_lshl_b32 s80, s72, 11
    s_lshl_b32 s82, s73, 17
    s_add_u32 s82, s82, 3145728
    s_add_u32 s82, s82, s80
    v_add_u32 v14, s82, v2
    s_lshl_b32 s77, s16, 13
    v_add_u32 v12, 65536, v2
    s_lshl_b32 s82, s72, 17
    s_add_u32 s82, s82, 2621440
    v_add_u32 v31, s82, v2
    s_and_b32 s82, s74, 0
    s_lshl_b32 s82, s82, 15
    s_add_u32 s23, s82, 65536
    s_xor_b32 s28, s23, 0x8000
    s_lshl_b32 s82, s74, 2
    s_add_u32 s82, s82, s72
    s_lshl_b32 s82, s82, 14
    s_add_u32 s82, s82, 1572864
    v_add_u32 v15, s82, v2
    s_lshl_b32 s78, s16, 10
    s_waitcnt lgkmcnt(0)
    s_barrier
    ds_read_b128 v[48:51], v2 offset:0
    ds_read_b128 v[52:55], v2 offset:1024
    ds_read_b128 v[56:59], v2 offset:2048
    ds_read_b128 v[60:63], v2 offset:3072
    ds_read_b128 v[64:67], v2 offset:4096
    ds_read_b128 v[68:71], v2 offset:5120
    ds_read_b128 v[72:75], v2 offset:6144
    ds_read_b128 v[76:79], v2 offset:7168
    ds_read_b128 v[80:83], v2 offset:16
    s_waitcnt vmcnt(29) lgkmcnt(8)
    v_mfma_f32_16x16x32_bf16 v[32:35], a[0:3], v[48:51], 0
    ds_read_b128 v[84:87], v2 offset:8192
    s_waitcnt vmcnt(28) lgkmcnt(8)
    v_mfma_f32_16x16x32_bf16 v[32:35], a[4:7], v[52:55], v[32:35]
    ds_read_b128 v[88:91], v2 offset:9216
    s_waitcnt vmcnt(27) lgkmcnt(8)
    v_mfma_f32_16x16x32_bf16 v[32:35], a[8:11], v[56:59], v[32:35]
    ds_read_b128 v[92:95], v2 offset:10240
    v_mfma_f32_16x16x32_bf16 v[36:39], a[0:3], v[56:59], 0
    ds_read_b128 v[96:99], v2 offset:11264
    s_waitcnt lgkmcnt(9)
    v_mfma_f32_16x16x32_bf16 v[36:39], a[4:7], v[60:63], v[36:39]
    ds_read_b128 v[100:103], v2 offset:12288
    s_waitcnt lgkmcnt(9)
    v_mfma_f32_16x16x32_bf16 v[36:39], a[8:11], v[64:67], v[36:39]
    ds_read_b128 v[104:107], v2 offset:13312
    v_mfma_f32_16x16x32_bf16 v[40:43], a[0:3], v[64:67], 0
    ds_read_b128 v[108:111], v2 offset:14336
    s_waitcnt lgkmcnt(10)
    v_mfma_f32_16x16x32_bf16 v[40:43], a[4:7], v[68:71], v[40:43]
    ds_read_b128 v[112:115], v2 offset:15360
    s_waitcnt lgkmcnt(10)
    v_mfma_f32_16x16x32_bf16 v[40:43], a[8:11], v[72:75], v[40:43]
    ds_read_b128 v[116:119], v2 offset:8208
    v_mfma_f32_16x16x32_bf16 v[44:47], a[0:3], v[72:75], 0
    s_waitcnt lgkmcnt(10)
    v_mfma_f32_16x16x32_bf16 v[44:47], a[4:7], v[76:79], v[44:47]
    s_waitcnt lgkmcnt(9)
    v_mfma_f32_16x16x32_bf16 v[44:47], a[8:11], v[80:83], v[44:47]
    s_waitcnt vmcnt(26) lgkmcnt(8)
    v_mfma_f32_16x16x32_bf16 v[32:35], a[12:15], v[84:87], v[32:35]
    s_waitcnt vmcnt(25) lgkmcnt(7)
    v_mfma_f32_16x16x32_bf16 v[32:35], a[16:19], v[88:91], v[32:35]
    s_waitcnt vmcnt(24) lgkmcnt(6)
    v_mfma_f32_16x16x32_bf16 v[32:35], a[20:23], v[92:95], v[32:35]
    v_mfma_f32_16x16x32_bf16 v[36:39], a[12:15], v[92:95], v[36:39]
    s_waitcnt lgkmcnt(5)
    v_mfma_f32_16x16x32_bf16 v[36:39], a[16:19], v[96:99], v[36:39]
    s_waitcnt lgkmcnt(4)
    v_mfma_f32_16x16x32_bf16 v[36:39], a[20:23], v[100:103], v[36:39]
    v_mfma_f32_16x16x32_bf16 v[40:43], a[12:15], v[100:103], v[40:43]
    s_waitcnt lgkmcnt(3)
    v_mfma_f32_16x16x32_bf16 v[40:43], a[16:19], v[104:107], v[40:43]
    s_waitcnt lgkmcnt(2)
    v_mfma_f32_16x16x32_bf16 v[40:43], a[20:23], v[108:111], v[40:43]
    v_mfma_f32_16x16x32_bf16 v[44:47], a[12:15], v[108:111], v[44:47]
    s_waitcnt lgkmcnt(1)
    v_mfma_f32_16x16x32_bf16 v[44:47], a[16:19], v[112:115], v[44:47]
    s_waitcnt lgkmcnt(0)
    v_mfma_f32_16x16x32_bf16 v[44:47], a[20:23], v[116:119], v[44:47]
    s_add_u32 s77, s77, 8192
    s_and_b32 s77, s77, 0x1ffff
    v_mov_b32 v5, 1
    v_mov_b32 v6, 0
    s_waitcnt vmcnt(4)
    s_waitcnt lgkmcnt(0)
    s_cmp_eq_u32 s21, 2
    s_barrier
    s_cbranch_scc0 L_fl_11
    s_mov_b64 exec, 1
    buffer_store_dword v5, v6, s[44:47], s96 offen
    s_mov_b64 exec, -1
L_fl_11:
    s_cmp_eq_u32 s21, 1
    s_cbranch_scc0 L_fg_12
    s_mov_b64 exec, 1
    buffer_store_dword v5, v6, s[44:47], s96 offen sc1
    s_mov_b64 exec, -1
L_fg_12:
    s_cmp_eq_u32 s72, 2
    s_cbranch_scc0 L_ng_13
    v_add_u32 v7, 155904, v2
    ds_read_b128 v[136:139], v7 offset:0
    ds_read_b128 v[140:143], v7 offset:1024
    ds_read_b128 v[144:147], v7 offset:2048
    ds_read_b128 v[148:151], v7 offset:3072
    v_lshlrev_b32 v7, 4, v3
    v_lshl_add_u32 v7, v4, 7, v7
    v_cmp_gt_u32 vcc, 8, v3
    v_mov_b32 v8, 0x7ff00000
    s_nop 0
    v_cndmask_b32 v7, v8, v7, vcc
    s_and_b32 s82, s2, 7
    s_lshl_b32 s82, s82, 14
    s_lshr_b32 s83, s2, 3
    s_lshl_b32 s83, s83, 9
    s_add_u32 s82, s82, s83
    s_add_u32 s82, s82, 13631488
    s_mov_b32 s83, 0x4038aa3b
    s_waitcnt lgkmcnt(0)
    v_add_f32 v136, v136, v140
    v_add_f32 v144, v144, v148
    v_add_f32 v137, v137, v141
    v_add_f32 v145, v145, v149
    v_add_f32 v138, v138, v142
    v_add_f32 v146, v146, v150
    v_add_f32 v139, v139, v143
    v_add_f32 v147, v147, v151
    v_add_f32 v136, v136, v144
    v_add_f32 v137, v137, v145
    v_add_f32 v138, v138, v146
    v_add_f32 v139, v139, v147
    v_mul_f32 v136, s83, v136
    v_mul_f32 v137, s83, v137
    v_mul_f32 v138, s83, v138
    v_mul_f32 v139, s83, v139
    buffer_store_dwordx4 v[136:139], v7, s[44:47], s82 offen sc1
    s_nop 1
L_ng_13:
    buffer_load_dwordx4 a[104:107], v2, s[44:47], s3 offen offset:2048 sc1
    s_add_u32 s79, s79, 1
    s_and_b32 s79, s79, 15
    s_mul_i32 s3, s79, 3072
    s_add_u32 s3, s3, s7
    buffer_load_dwordx4 a[108:111], v2, s[44:47], s3 offen offset:0 sc1
    buffer_load_dwordx4 a[112:115], v2, s[44:47], s3 offen offset:1024 sc1
    buffer_load_dwordx4 a[116:119], v2, s[44:47], s3 offen offset:2048 sc1
    s_add_u32 s79, s79, 1
    s_and_b32 s79, s79, 15
    s_mul_i32 s3, s79, 3072
    s_add_u32 s3, s3, s7
    buffer_load_dwordx4 a[120:123], v2, s[44:47], s3 offen offset:0 sc1
    buffer_load_dwordx4 a[124:127], v2, s[44:47], s3 offen offset:1024 sc1
    buffer_load_dwordx4 a[128:131], v2, s[44:47], s3 offen offset:2048 sc1
    s_add_u32 s79, s79, 1
    s_and_b32 s79, s79, 15
    s_mul_i32 s3, s79, 3072
    s_add_u32 s3, s3, s7
    buffer_load_dwordx4 a[132:135], v2, s[44:47], s3 offen offset:0 sc1
    s_cmp_eq_u32 s72, 1
    s_cbranch_scc0 L_polld_15
    s_mov_b32 s94, 60000
L_poll_14:
    buffer_load_dword v5, v0, s[44:47], s95 offen sc1
    s_waitcnt vmcnt(0)
    v_cmp_le_u32 vcc, 1, v5
    s_nop 0
    s_cmp_eq_u64 vcc, -1
    s_cbranch_scc1 L_polld_15
    s_sub_u32 s94, s94, 1
    s_cmp_lg_u32 s94, 0
    s_cbranch_scc1 L_poll_14
L_polld_15:
    s_barrier
    s_add_u32 s77, s77, 8192
    s_add_u32 m0, s80, 16384
    s_and_b32 s77, s77, 0x1ffff
    buffer_load_dwordx4 v14, s[44:47], s77 offen sc1 lds
    buffer_load_dwordx4 v14, s[44:47], s77 offen offset:1024 sc1 lds
    s_add_u32 s77, s77, 8192
    s_add_u32 m0, s80, 24576
    s_and_b32 s77, s77, 0x1ffff
    buffer_load_dwordx4 v14, s[44:47], s77 offen sc1 lds
    buffer_load_dwordx4 v14, s[44:47], s77 offen offset:1024 sc1 lds
    s_add_u32 s77, s77, 8192
    s_add_u32 m0, s80, 32768
    s_and_b32 s77, s77, 0x1ffff
    buffer_load_dwordx4 v14, s[44:47], s77 offen sc1 lds
    buffer_load_dwordx4 v14, s[44:47], s77 offen offset:1024 sc1 lds
    s_add_u32 s77, s77, 8192
    s_add_u32 m0, s80, 40960
    s_and_b32 s77, s77, 0x1ffff
    buffer_load_dwordx4 v14, s[44:47], s77 offen sc1 lds
    buffer_load_dwordx4 v14, s[44:47], s77 offen offset:1024 sc1 lds
    s_add_u32 s77, s77, 8192
    s_add_u32 m0, s80, 49152
    s_and_b32 s77, s77, 0x1ffff
    buffer_load_dwordx4 v14, s[44:47], s77 offen sc1 lds
    buffer_load_dwordx4 v14, s[44:47], s77 offen offset:1024 sc1 lds
    s_add_u32 s77, s77, 8192
    s_add_u32 m0, s80, 57344
    s_and_b32 s77, s77, 0x1ffff
    buffer_load_dwordx4 v14, s[44:47], s77 offen sc1 lds
    buffer_load_dwordx4 v14, s[44:47], s77 offen offset:1024 sc1 lds
    s_add_u32 s77, s77, 8192
    s_add_u32 m0, s80, 65536
    s_and_b32 s77, s77, 0x1ffff
    buffer_load_dwordx4 v14, s[44:47], s77 offen sc1 lds
    buffer_load_dwordx4 v14, s[44:47], s77 offen offset:1024 sc1 lds
    v_bfe_u32 v5, v1, 3, 2
    v_lshlrev_b32 v5, 7, v5
    v_and_b32 v6, 7, v1
    v_lshl_add_u32 v13, v6, 2, v5
    s_and_b32 s8, s2, 7
    s_lshl_b32 s8, s8, 9
    s_add_u32 s8, s8, 14221312
    s_lshl_b32 s82, s73, 16
    s_lshl_b32 s83, s74, 13
    s_add_u32 s82, s82, s83
    s_add_u32 s82, s82, s80
    s_add_u32 s83, s82, 7340032
    s_waitcnt vmcnt(12)
    s_barrier
    ds_read_b128 v[48:51], v2 offset:16384
    ds_read_b128 v[52:55], v2 offset:17408
    ds_read_b128 v[56:59], v2 offset:18432
    ds_read_b128 v[60:63], v2 offset:19456
    ds_read_b128 v[64:67], v2 offset:20480
    ds_read_b128 v[68:71], v2 offset:21504
    ds_read_b128 v[72:75], v2 offset:22528
    ds_read_b128 v[76:79], v2 offset:23552
    ds_read_b128 v[80:83], v2 offset:16400
    s_waitcnt lgkmcnt(8)
    v_mfma_f32_16x16x32_bf16 v[32:35], a[24:27], v[48:51], v[32:35]
    s_cmp_eq_u32 s72, 2
    s_cbranch_scc0 L_gp_16
    s_lshl_b32 s85, s73, 7
    s_lshl_b32 s86, s74, 2
    s_add_u32 s85, s85, s86
    s_add_u32 s85, s85, 14221312
    s_or_b32 s86, s18, 16
    v_mov_b32 v5, s86
    v_mov_b32 v6, 0
    s_mov_b64 exec, 1
    buffer_store_dword v5, v6, s[44:47], s85 offen sc1
    s_mov_b64 exec, -1
L_gp_16:
    s_waitcnt vmcnt(10)
    s_barrier
    s_add_u32 s77, s77, 8192
    s_add_u32 m0, s80, 73728
    s_and_b32 s77, s77, 0x1ffff
    buffer_load_dwordx4 v14, s[44:47], s77 offen sc1 lds
    s_waitcnt lgkmcnt(7)
    v_mfma_f32_16x16x32_bf16 v[32:35], a[28:31], v[52:55], v[32:35]
    ds_read_b128 v[84:87], v2 offset:24576
    s_waitcnt lgkmcnt(7)
    v_mfma_f32_16x16x32_bf16 v[32:35], a[32:35], v[56:59], v[32:35]
    ds_read_b128 v[88:91], v2 offset:25600
    v_mfma_f32_16x16x32_bf16 v[36:39], a[24:27], v[56:59], v[36:39]
    ds_read_b128 v[92:95], v2 offset:26624
    s_waitcnt lgkmcnt(8)
    v_mfma_f32_16x16x32_bf16 v[36:39], a[28:31], v[60:63], v[36:39]
    ds_read_b128 v[96:99], v2 offset:27648
    s_waitcnt lgkmcnt(8)
    v_mfma_f32_16x16x32_bf16 v[36:39], a[32:35], v[64:67], v[36:39]
    ds_read_b128 v[100:103], v2 offset:28672
    v_mfma_f32_16x16x32_bf16 v[40:43], a[24:27], v[64:67], v[40:43]
    ds_read_b128 v[104:107], v2 offset:29696
    s_waitcnt lgkmcnt(9)
    v_mfma_f32_16x16x32_bf16 v[40:43], a[28:31], v[68:71], v[40:43]
    ds_read_b128 v[108:111], v2 offset:30720
    s_waitcnt lgkmcnt(9)
    v_mfma_f32_16x16x32_bf16 v[40:43], a[32:35], v[72:75], v[40:43]
    ds_read_b128 v[112:115], v2 offset:31744
    v_mfma_f32_16x16x32_bf16 v[44:47], a[24:27], v[72:75], v[44:47]
    ds_read_b128 v[116:119], v2 offset:24592
    buffer_load_dwordx4 v14, s[44:47], s77 offen offset:1024 sc1 lds
    s_waitcnt lgkmcnt(10)
    v_mfma_f32_16x16x32_bf16 v[44:47], a[28:31], v[76:79], v[44:47]
    buffer_load_dwordx4 a[136:139], v2, s[44:47], s3 offen offset:1024 sc1
    s_waitcnt lgkmcnt(9)
    v_mfma_f32_16x16x32_bf16 v[44:47], a[32:35], v[80:83], v[44:47]
    buffer_load_dwordx4 a[140:143], v2, s[44:47], s3 offen offset:2048 sc1
    s_waitcnt lgkmcnt(8)
    v_mfma_f32_16x16x32_bf16 v[32:35], a[36:39], v[84:87], v[32:35]
    s_waitcnt vmcnt(10)
    s_barrier
    s_add_u32 s77, s77, 8192
    s_add_u32 m0, s80, 81920
    s_and_b32 s77, s77, 0x1ffff
    buffer_load_dwordx4 v14, s[44:47], s77 offen sc1 lds
    s_waitcnt lgkmcnt(7)
    v_mfma_f32_16x16x32_bf16 v[32:35], a[40:43], v[88:91], v[32:35]
    ds_read_b128 v[48:51], v2 offset:32768
    s_waitcnt lgkmcnt(7)
    v_mfma_f32_16x16x32_bf16 v[32:35], a[44:47], v[92:95], v[32:35]
    ds_read_b128 v[52:55], v2 offset:33792
    v_mfma_f32_16x16x32_bf16 v[36:39], a[36:39], v[92:95], v[36:39]
    ds_read_b128 v[56:59], v2 offset:34816
    s_waitcnt lgkmcnt(8)
    v_mfma_f32_16x16x32_bf16 v[36:39], a[40:43], v[96:99], v[36:39]
    ds_read_b128 v[60:63], v2 offset:35840
    s_waitcnt lgkmcnt(8)
    v_mfma_f32_16x16x32_bf16 v[36:39], a[44:47], v[100:103], v[36:39]
    ds_read_b128 v[64:67], v2 offset:36864
    v_mfma_f32_16x16x32_bf16 v[40:43], a[36:39], v[100:103], v[40:43]
    ds_read_b128 v[68:71], v2 offset:37888
    s_waitcnt lgkmcnt(9)
    v_mfma_f32_16x16x32_bf16 v[40:43], a[40:43], v[104:107], v[40:43]
    ds_read_b128 v[72:75], v2 offset:38912
    s_waitcnt lgkmcnt(9)
    v_mfma_f32_16x16x32_bf16 v[40:43], a[44:47], v[108:111], v[40:43]
    ds_read_b128 v[76:79], v2 offset:39936
    v_mfma_f32_16x16x32_bf16 v[44:47], a[36:39], v[108:111], v[44:47]
    ds_read_b128 v[80:83], v2 offset:32784
    buffer_load_dwordx4 v14, s[44:47], s77 offen offset:1024 sc1 lds
    s_waitcnt lgkmcnt(10)
    v_mfma_f32_16x16x32_bf16 v[44:47], a[40:43], v[112:115], v[44:47]
    s_add_u32 s79, s79, 1
    s_and_b32 s79, s79, 15
    s_mul_i32 s3, s79, 3072
    s_add_u32 s3, s3, s7
    buffer_load_dwordx4 a[144:147], v2, s[44:47], s3 offen offset:0 sc1
    s_waitcnt lgkmcnt(9)
    v_mfma_f32_16x16x32_bf16 v[44:47], a[44:47], v[116:119], v[44:47]
    buffer_load_dwordx4 a[148:151], v2, s[44:47], s3 offen offset:1024 sc1
    s_waitcnt lgkmcnt(8)
    v_mfma_f32_16x16x32_bf16 v[32:35], a[48:51], v[48:51], v[32:35]
    ds_read_b128 v[84:87], v2 offset:40960
    s_waitcnt lgkmcnt(8)
    v_mfma_f32_16x16x32_bf16 v[32:35], a[52:55], v[52:55], v[32:35]
    ds_read_b128 v[88:91], v2 offset:41984
    s_waitcnt lgkmcnt(8)
    v_mfma_f32_16x16x32_bf16 v[32:35], a[56:59], v[56:59], v[32:35]
    ds_read_b128 v[92:95], v2 offset:43008
    v_mfma_f32_16x16x32_bf16 v[36:39], a[48:51], v[56:59], v[36:39]
    ds_read_b128 v[96:99], v2 offset:44032
    s_waitcnt lgkmcnt(9)
    v_mfma_f32_16x16x32_bf16 v[36:39], a[52:55], v[60:63], v[36:39]
    ds_read_b128 v[100:103], v2 offset:45056
    s_waitcnt lgkmcnt(9)
    v_mfma_f32_16x16x32_bf16 v[36:39], a[56:59], v[64:67], v[36:39]
    ds_read_b128 v[104:107], v2 offset:46080
    v_mfma_f32_16x16x32_bf16 v[40:43], a[48:51], v[64:67], v[40:43]
    s_add_u32 s77, s77, 8192
    s_add_u32 m0, s80, 90112
    s_and_b32 s77, s77, 0x1ffff
    buffer_load_dwordx4 v14, s[44:47], s77 offen sc1 lds
    s_waitcnt lgkmcnt(9)
    v_mfma_f32_16x16x32_bf16 v[40:43], a[52:55], v[68:71], v[40:43]
    ds_read_b128 v[108:111], v2 offset:47104
    s_waitcnt lgkmcnt(9)
    v_mfma_f32_16x16x32_bf16 v[40:43], a[56:59], v[72:75], v[40:43]
    ds_read_b128 v[112:115], v2 offset:48128
    v_mfma_f32_16x16x32_bf16 v[44:47], a[48:51], v[72:75], v[44:47]
    ds_read_b128 v[116:119], v2 offset:40976
    buffer_load_dwordx4 v14, s[44:47], s77 offen offset:1024 sc1 lds
    s_waitcnt lgkmcnt(10)
    v_mfma_f32_16x16x32_bf16 v[44:47], a[52:55], v[76:79], v[44:47]
    buffer_load_dwordx4 a[152:155], v2, s[44:47], s3 offen offset:2048 sc1
    s_waitcnt lgkmcnt(9)
    v_mfma_f32_16x16x32_bf16 v[44:47], a[56:59], v[80:83], v[44:47]
    s_add_u32 s79, s79, 1
    s_and_b32 s79, s79, 15
    s_mul_i32 s3, s79, 3072
    s_add_u32 s3, s3, s7
    buffer_load_dwordx4 a[156:159], v2, s[44:47], s3 offen offset:0 sc1
    s_waitcnt lgkmcnt(8)
    v_mfma_f32_16x16x32_bf16 v[32:35], a[60:63], v[84:87], v[32:35]
    s_waitcnt vmcnt(14)
    s_barrier
    s_add_u32 s77, s77, 8192
    s_add_u32 m0, s80, 98304
    s_and_b32 s77, s77, 0x1ffff
    buffer_load_dwordx4 v14, s[44:47], s77 offen sc1 lds
    s_waitcnt lgkmcnt(7)
    v_mfma_f32_16x16x32_bf16 v[32:35], a[64:67], v[88:91], v[32:35]
    ds_read_b128 v[48:51], v2 offset:49152
    s_waitcnt lgkmcnt(7)
    v_mfma_f32_16x16x32_bf16 v[32:35], a[68:71], v[92:95], v[32:35]
    ds_read_b128 v[52:55], v2 offset:50176
    v_mfma_f32_16x16x32_bf16 v[36:39], a[60:63], v[92:95], v[36:39]
    ds_read_b128 v[56:59], v2 offset:51200
    s_waitcnt lgkmcnt(8)
    v_mfma_f32_16x16x32_bf16 v[36:39], a[64:67], v[96:99], v[36:39]
    ds_read_b128 v[60:63], v2 offset:52224
    s_waitcnt lgkmcnt(8)
    v_mfma_f32_16x16x32_bf16 v[36:39], a[68:71], v[100:103], v[36:39]
    ds_read_b128 v[64:67], v2 offset:53248
    v_mfma_f32_16x16x32_bf16 v[40:43], a[60:63], v[100:103], v[40:43]
    ds_read_b128 v[68:71], v2 offset:54272
    s_waitcnt lgkmcnt(9)
    v_mfma_f32_16x16x32_bf16 v[40:43], a[64:67], v[104:107], v[40:43]
    ds_read_b128 v[72:75], v2 offset:55296
    s_waitcnt lgkmcnt(9)
    v_mfma_f32_16x16x32_bf16 v[40:43], a[68:71], v[108:111], v[40:43]
    ds_read_b128 v[76:79], v2 offset:56320
    v_mfma_f32_16x16x32_bf16 v[44:47], a[60:63], v[108:111], v[44:47]
    ds_read_b128 v[80:83], v2 offset:49168
    buffer_load_dwordx4 v14, s[44:47], s77 offen offset:1024 sc1 lds
    s_waitcnt lgkmcnt(10)
    v_mfma_f32_16x16x32_bf16 v[44:47], a[64:67], v[112:115], v[44:47]
    buffer_load_dwordx4 a[160:163], v2, s[44:47], s3 offen offset:1024 sc1
    s_waitcnt lgkmcnt(9)
    v_mfma_f32_16x16x32_bf16 v[44:47], a[68:71], v[116:119], v[44:47]
    buffer_load_dwordx4 a[164:167], v2, s[44:47], s3 offen offset:2048 sc1
    s_waitcnt lgkmcnt(8)
    v_mfma_f32_16x16x32_bf16 v[32:35], a[72:75], v[48:51], v[32:35]
    ds_read_b128 v[84:87], v2 offset:57344
    s_waitcnt lgkmcnt(8)
    v_mfma_f32_16x16x32_bf16 v[32:35], a[76:79], v[52:55], v[32:35]
    ds_read_b128 v[88:91], v2 offset:58368
    s_waitcnt lgkmcnt(8)
    v_mfma_f32_16x16x32_bf16 v[32:35], a[80:83], v[56:59], v[32:35]
    ds_read_b128 v[92:95], v2 offset:59392
    v_mfma_f32_16x16x32_bf16 v[36:39], a[72:75], v[56:59], v[36:39]
    ds_read_b128 v[96:99], v2 offset:60416
    s_waitcnt lgkmcnt(9)
    v_mfma_f32_16x16x32_bf16 v[36:39], a[76:79], v[60:63], v[36:39]
    ds_read_b128 v[100:103], v2 offset:61440
    s_waitcnt lgkmcnt(9)
    v_mfma_f32_16x16x32_bf16 v[36:39], a[80:83], v[64:67], v[36:39]
    ds_read_b128 v[104:107], v2 offset:62464
    v_mfma_f32_16x16x32_bf16 v[40:43], a[72:75], v[64:67], v[40:43]
    s_add_u32 s77, s77, 8192
    s_add_u32 m0, s80, 106496
    s_and_b32 s77, s77, 0x1ffff
    buffer_load_dwordx4 v14, s[44:47], s77 offen sc1 lds
    s_waitcnt lgkmcnt(9)
    v_mfma_f32_16x16x32_bf16 v[40:43], a[76:79], v[68:71], v[40:43]
    ds_read_b128 v[108:111], v2 offset:63488
    s_waitcnt lgkmcnt(9)
    v_mfma_f32_16x16x32_bf16 v[40:43], a[80:83], v[72:75], v[40:43]
    ds_read_b128 v[112:115], v2 offset:64512
    v_mfma_f32_16x16x32_bf16 v[44:47], a[72:75], v[72:75], v[44:47]
    ds_read_b128 v[116:119], v2 offset:57360
    buffer_load_dwordx4 v14, s[44:47], s77 offen offset:1024 sc1 lds
    s_waitcnt lgkmcnt(10)
    v_mfma_f32_16x16x32_bf16 v[44:47], a[76:79], v[76:79], v[44:47]
    s_add_u32 s79, s79, 1
    s_and_b32 s79, s79, 15
    s_mul_i32 s3, s79, 3072
    s_add_u32 s3, s3, s7
    buffer_load_dwordx4 a[168:171], v2, s[44:47], s3 offen offset:0 sc1
    s_waitcnt lgkmcnt(9)
    v_mfma_f32_16x16x32_bf16 v[44:47], a[80:83], v[80:83], v[44:47]
    buffer_load_dwordx4 a[172:175], v2, s[44:47], s3 offen offset:1024 sc1
    s_waitcnt lgkmcnt(8)
    v_mfma_f32_16x16x32_bf16 v[32:35], a[84:87], v[84:87], v[32:35]
    s_waitcnt vmcnt(18)
    s_barrier
    s_add_u32 s77, s77, 8192
    s_add_u32 m0, s80, 114688
    s_and_b32 s77, s77, 0x1ffff
    buffer_load_dwordx4 v14, s[44:47], s77 offen sc1 lds
    s_waitcnt lgkmcnt(7)
    v_mfma_f32_16x16x32_bf16 v[32:35], a[88:91], v[88:91], v[32:35]
    ds_read_b128 v[48:51], v12 offset:0
    s_waitcnt lgkmcnt(7)
    v_mfma_f32_16x16x32_bf16 v[32:35], a[92:95], v[92:95], v[32:35]
    ds_read_b128 v[52:55], v12 offset:1024
    v_mfma_f32_16x16x32_bf16 v[36:39], a[84:87], v[92:95], v[36:39]
    ds_read_b128 v[56:59], v12 offset:2048
    s_waitcnt lgkmcnt(8)
    v_mfma_f32_16x16x32_bf16 v[36:39], a[88:91], v[96:99], v[36:39]
    ds_read_b128 v[60:63], v12 offset:3072
    s_waitcnt lgkmcnt(8)
    v_mfma_f32_16x16x32_bf16 v[36:39], a[92:95], v[100:103], v[36:39]
    ds_read_b128 v[64:67], v12 offset:4096
    v_mfma_f32_16x16x32_bf16 v[40:43], a[84:87], v[100:103], v[40:43]
    ds_read_b128 v[68:71], v12 offset:5120
    s_waitcnt lgkmcnt(9)
    v_mfma_f32_16x16x32_bf16 v[40:43], a[88:91], v[104:107], v[40:43]
    ds_read_b128 v[72:75], v12 offset:6144
    s_waitcnt lgkmcnt(9)
    v_mfma_f32_16x16x32_bf16 v[40:43], a[92:95], v[108:111], v[40:43]
    ds_read_b128 v[76:79], v12 offset:7168
    v_mfma_f32_16x16x32_bf16 v[44:47], a[84:87], v[108:111], v[44:47]
    ds_read_b128 v[80:83], v12 offset:16
    buffer_load_dwordx4 v14, s[44:47], s77 offen offset:1024 sc1 lds
    s_waitcnt lgkmcnt(10)
    v_mfma_f32_16x16x32_bf16 v[44:47], a[88:91], v[112:115], v[44:47]
    buffer_load_dwordx4 a[176:179], v2, s[44:47], s3 offen offset:2048 sc1
    s_waitcnt lgkmcnt(9)
    v_mfma_f32_16x16x32_bf16 v[44:47], a[92:95], v[116:119], v[44:47]
    s_add_u32 s79, s79, 1
    s_and_b32 s79, s79, 15
    s_mul_i32 s3, s79, 3072
    s_add_u32 s3, s3, s7
    buffer_load_dwordx4 a[180:183], v2, s[44:47], s3 offen offset:0 sc1
    s_waitcnt lgkmcnt(8)
    v_mfma_f32_16x16x32_bf16 v[32:35], a[96:99], v[48:51], v[32:35]
    ds_read_b128 v[84:87], v12 offset:8192
    s_waitcnt lgkmcnt(8)
    v_mfma_f32_16x16x32_bf16 v[32:35], a[100:103], v[52:55], v[32:35]
    ds_read_b128 v[88:91], v12 offset:9216
    s_waitcnt lgkmcnt(8)
    v_mfma_f32_16x16x32_bf16 v[32:35], a[104:107], v[56:59], v[32:35]
    ds_read_b128 v[92:95], v12 offset:10240
    v_mfma_f32_16x16x32_bf16 v[36:39], a[96:99], v[56:59], v[36:39]
    ds_read_b128 v[96:99], v12 offset:11264
    s_waitcnt lgkmcnt(9)
    v_mfma_f32_16x16x32_bf16 v[36:39], a[100:103], v[60:63], v[36:39]
    ds_read_b128 v[100:103], v12 offset:12288
    s_waitcnt lgkmcnt(9)
    v_mfma_f32_16x16x32_bf16 v[36:39], a[104:107], v[64:67], v[36:39]
    ds_read_b128 v[104:107], v12 offset:13312
    v_mfma_f32_16x16x32_bf16 v[40:43], a[96:99], v[64:67], v[40:43]
    s_add_u32 s77, s77, 8192
    s_add_u32 m0, s80, 122880
    s_and_b32 s77, s77, 0x1ffff
    buffer_load_dwordx4 v14, s[44:47], s77 offen sc1 lds
    s_waitcnt lgkmcnt(9)
    v_mfma_f32_16x16x32_bf16 v[40:43], a[100:103], v[68:71], v[40:43]
    ds_read_b128 v[108:111], v12 offset:14336
    s_waitcnt lgkmcnt(9)
    v_mfma_f32_16x16x32_bf16 v[40:43], a[104:107], v[72:75], v[40:43]
    ds_read_b128 v[112:115], v12 offset:15360
    v_mfma_f32_16x16x32_bf16 v[44:47], a[96:99], v[72:75], v[44:47]
    ds_read_b128 v[116:119], v12 offset:8208
    buffer_load_dwordx4 v14, s[44:47], s77 offen offset:1024 sc1 lds
    s_waitcnt lgkmcnt(10)
    v_mfma_f32_16x16x32_bf16 v[44:47], a[100:103], v[76:79], v[44:47]
    buffer_load_dwordx4 a[184:187], v2, s[44:47], s3 offen offset:1024 sc1
    s_waitcnt lgkmcnt(9)
    v_mfma_f32_16x16x32_bf16 v[44:47], a[104:107], v[80:83], v[44:47]
    buffer_load_dwordx4 a[188:191], v2, s[44:47], s3 offen offset:2048 sc1
    s_waitcnt lgkmcnt(8)
    v_mfma_f32_16x16x32_bf16 v[32:35], a[108:111], v[84:87], v[32:35]
    s_waitcnt vmcnt(18)
    s_barrier
    s_waitcnt lgkmcnt(7)
    v_mfma_f32_16x16x32_bf16 v[32:35], a[112:115], v[88:91], v[32:35]
    ds_read_b128 v[48:51], v12 offset:16384
    s_waitcnt lgkmcnt(7)
    v_mfma_f32_16x16x32_bf16 v[32:35], a[116:119], v[92:95], v[32:35]
    ds_read_b128 v[52:55], v12 offset:17408
    v_mfma_f32_16x16x32_bf16 v[36:39], a[108:111], v[92:95], v[36:39]
    ds_read_b128 v[56:59], v12 offset:18432
    s_waitcnt lgkmcnt(8)
    v_mfma_f32_16x16x32_bf16 v[36:39], a[112:115], v[96:99], v[36:39]
    ds_read_b128 v[60:63], v12 offset:19456
    s_waitcnt lgkmcnt(8)
    v_mfma_f32_16x16x32_bf16 v[36:39], a[116:119], v[100:103], v[36:39]
    ds_read_b128 v[64:67], v12 offset:20480
    v_mfma_f32_16x16x32_bf16 v[40:43], a[108:111], v[100:103], v[40:43]
    ds_read_b128 v[68:71], v12 offset:21504
    s_waitcnt lgkmcnt(9)
    v_mfma_f32_16x16x32_bf16 v[40:43], a[112:115], v[104:107], v[40:43]
    ds_read_b128 v[72:75], v12 offset:22528
    s_waitcnt lgkmcnt(9)
    v_mfma_f32_16x16x32_bf16 v[40:43], a[116:119], v[108:111], v[40:43]
    ds_read_b128 v[76:79], v12 offset:23552
    s_nop 0
    s_nop 0
L_PAD3:
    s_cbranch_execz L_PADRET
    v_mfma_f32_16x16x32_bf16 v[44:47], a[108:111], v[108:111], v[44:47]
    ds_read_b128 v[80:83], v12 offset:16400
    s_waitcnt lgkmcnt(10)
    v_mfma_f32_16x16x32_bf16 v[44:47], a[112:115], v[112:115], v[44:47]
    s_waitcnt lgkmcnt(9)
    v_mfma_f32_16x16x32_bf16 v[44:47], a[116:119], v[116:119], v[44:47]
    s_waitcnt lgkmcnt(8)
    v_mfma_f32_16x16x32_bf16 v[32:35], a[120:123], v[48:51], v[32:35]
    ds_read_b128 v[84:87], v12 offset:24576
    s_waitcnt lgkmcnt(8)
    v_mfma_f32_16x16x32_bf16 v[32:35], a[124:127], v[52:55], v[32:35]
    ds_read_b128 v[88:91], v12 offset:25600
    s_waitcnt lgkmcnt(8)
    v_mfma_f32_16x16x32_bf16 v[32:35], a[128:131], v[56:59], v[32:35]
    ds_read_b128 v[92:95], v12 offset:26624
    v_mfma_f32_16x16x32_bf16 v[36:39], a[120:123], v[56:59], v[36:39]
    ds_read_b128 v[96:99], v12 offset:27648
    s_waitcnt lgkmcnt(9)
    v_mfma_f32_16x16x32_bf16 v[36:39], a[124:127], v[60:63], v[36:39]
    ds_read_b128 v[100:103], v12 offset:28672
    s_waitcnt lgkmcnt(9)
    v_mfma_f32_16x16x32_bf16 v[36:39], a[128:131], v[64:67], v[36:39]
    ds_read_b128 v[104:107], v12 offset:29696
    v_mfma_f32_16x16x32_bf16 v[40:43], a[120:123], v[64:67], v[40:43]
    ds_read_b128 v[108:111], v12 offset:30720
    s_waitcnt lgkmcnt(10)
    v_mfma_f32_16x16x32_bf16 v[40:43], a[124:127], v[68:71], v[40:43]
    ds_read_b128 v[112:115], v12 offset:31744
    s_waitcnt lgkmcnt(10)
    v_mfma_f32_16x16x32_bf16 v[40:43], a[128:131], v[72:75], v[40:43]
    buffer_load_dwordx4 v[192:195], v15, s[44:47], s78 offen offset:0 sc1
    v_mfma_f32_16x16x32_bf16 v[44:47], a[120:123], v[72:75], v[44:47]
    ds_read_b128 v[116:119], v12 offset:24592
    s_waitcnt lgkmcnt(10)
    v_mfma_f32_16x16x32_bf16 v[44:47], a[124:127], v[76:79], v[44:47]
    buffer_load_dwordx4 v[196:199], v15, s[44:47], s78 offen offset:1024 sc1
    s_waitcnt lgkmcnt(9)
    v_mfma_f32_16x16x32_bf16 v[44:47], a[128:131], v[80:83], v[44:47]
    s_add_u32 s78, s78, 2048
    s_and_b32 s78, s78, 0x3fff
    buffer_load_dwordx4 v[200:203], v15, s[44:47], s78 offen offset:0 sc1
    s_waitcnt lgkmcnt(8)
    v_mfma_f32_16x16x32_bf16 v[32:35], a[132:135], v[84:87], v[32:35]
    s_waitcnt vmcnt(13)
    s_barrier
    buffer_load_dwordx4 v[204:207], v15, s[44:47], s78 offen offset:1024 sc1
    s_waitcnt lgkmcnt(7)
    v_mfma_f32_16x16x32_bf16 v[32:35], a[136:139], v[88:91], v[32:35]
    ds_read_b128 v[48:51], v12 offset:32768
    s_waitcnt lgkmcnt(7)
    v_mfma_f32_16x16x32_bf16 v[32:35], a[140:143], v[92:95], v[32:35]
    ds_read_b128 v[52:55], v12 offset:33792
    v_mfma_f32_16x16x32_bf16 v[36:39], a[132:135], v[92:95], v[36:39]
    ds_read_b128 v[56:59], v12 offset:34816
    s_waitcnt lgkmcnt(8)
    v_mfma_f32_16x16x32_bf16 v[36:39], a[136:139], v[96:99], v[36:39]
    ds_read_b128 v[60:63], v12 offset:35840
    s_waitcnt lgkmcnt(8)
    v_mfma_f32_16x16x32_bf16 v[36:39], a[140:143], v[100:103], v[36:39]
    ds_read_b128 v[64:67], v12 offset:36864
    v_mfma_f32_16x16x32_bf16 v[40:43], a[132:135], v[100:103], v[40:43]
    ds_read_b128 v[68:71], v12 offset:37888
    s_waitcnt lgkmcnt(9)
    v_mfma_f32_16x16x32_bf16 v[40:43], a[136:139], v[104:107], v[40:43]
    ds_read_b128 v[72:75], v12 offset:38912
    s_waitcnt lgkmcnt(9)
    v_mfma_f32_16x16x32_bf16 v[40:43], a[140:143], v[108:111], v[40:43]
    ds_read_b128 v[76:79], v12 offset:39936
    v_mfma_f32_16x16x32_bf16 v[44:47], a[132:135], v[108:111], v[44:47]
    ds_read_b128 v[80:83], v12 offset:32784
    s_waitcnt lgkmcnt(10)
    v_mfma_f32_16x16x32_bf16 v[44:47], a[136:139], v[112:115], v[44:47]
    s_add_u32 s78, s78, 2048
    s_and_b32 s78, s78, 0x3fff
    buffer_load_dwordx4 v[208:211], v15, s[44:47], s78 offen offset:0 sc1
    s_waitcnt lgkmcnt(9)
    v_mfma_f32_16x16x32_bf16 v[44:47], a[140:143], v[116:119], v[44:47]
    buffer_load_dwordx4 v[212:215], v15, s[44:47], s78 offen offset:1024 sc1
    s_waitcnt lgkmcnt(8)
    v_mfma_f32_16x16x32_bf16 v[32:35], a[144:147], v[48:51], v[32:35]
    ds_read_b128 v[84:87], v12 offset:40960
    s_waitcnt lgkmcnt(8)
    v_mfma_f32_16x16x32_bf16 v[32:35], a[148:151], v[52:55], v[32:35]
    ds_read_b128 v[88:91], v12 offset:41984
    s_waitcnt lgkmcnt(8)
    v_mfma_f32_16x16x32_bf16 v[32:35], a[152:155], v[56:59], v[32:35]
    ds_read_b128 v[92:95], v12 offset:43008
    v_mfma_f32_16x16x32_bf16 v[36:39], a[144:147], v[56:59], v[36:39]
    ds_read_b128 v[96:99], v12 offset:44032
    s_waitcnt lgkmcnt(9)
    v_mfma_f32_16x16x32_bf16 v[36:39], a[148:151], v[60:63], v[36:39]
    ds_read_b128 v[100:103], v12 offset:45056
    s_waitcnt lgkmcnt(9)
    v_mfma_f32_16x16x32_bf16 v[36:39], a[152:155], v[64:67], v[36:39]
    ds_read_b128 v[104:107], v12 offset:46080
    v_mfma_f32_16x16x32_bf16 v[40:43], a[144:147], v[64:67], v[40:43]
    ds_read_b128 v[108:111], v12 offset:47104
    s_waitcnt lgkmcnt(10)
    v_mfma_f32_16x16x32_bf16 v[40:43], a[148:151], v[68:71], v[40:43]
    ds_read_b128 v[112:115], v12 offset:48128
    s_waitcnt lgkmcnt(10)
    v_mfma_f32_16x16x32_bf16 v[40:43], a[152:155], v[72:75], v[40:43]
    ds_read_b128 v[116:119], v12 offset:40976
    v_mfma_f32_16x16x32_bf16 v[44:47], a[144:147], v[72:75], v[44:47]
    s_add_u32 s78, s78, 2048
    s_and_b32 s78, s78, 0x3fff
    buffer_load_dwordx4 v[216:219], v15, s[44:47], s78 offen offset:0 sc1
    s_waitcnt lgkmcnt(10)
    v_mfma_f32_16x16x32_bf16 v[44:47], a[148:151], v[76:79], v[44:47]
    buffer_load_dwordx4 v[220:223], v15, s[44:47], s78 offen offset:1024 sc1
    s_waitcnt lgkmcnt(9)
    v_mfma_f32_16x16x32_bf16 v[44:47], a[152:155], v[80:83], v[44:47]
    s_add_u32 s78, s78, 2048
    s_and_b32 s78, s78, 0x3fff
    buffer_load_dwordx4 v[224:227], v15, s[44:47], s78 offen offset:0 sc1
    s_waitcnt lgkmcnt(8)
    v_mfma_f32_16x16x32_bf16 v[32:35], a[156:159], v[84:87], v[32:35]
    s_waitcnt vmcnt(11)
    s_barrier
    s_waitcnt lgkmcnt(7)
    v_mfma_f32_16x16x32_bf16 v[32:35], a[160:163], v[88:91], v[32:35]
    ds_read_b128 v[48:51], v12 offset:49152
    s_waitcnt lgkmcnt(7)
    v_mfma_f32_16x16x32_bf16 v[32:35], a[164:167], v[92:95], v[32:35]
    ds_read_b128 v[52:55], v12 offset:50176
    v_mfma_f32_16x16x32_bf16 v[36:39], a[156:159], v[92:95], v[36:39]
    ds_read_b128 v[56:59], v12 offset:51200
    s_waitcnt lgkmcnt(8)
    v_mfma_f32_16x16x32_bf16 v[36:39], a[160:163], v[96:99], v[36:39]
    ds_read_b128 v[60:63], v12 offset:52224
    s_waitcnt lgkmcnt(8)
    v_mfma_f32_16x16x32_bf16 v[36:39], a[164:167], v[100:103], v[36:39]
    ds_read_b128 v[64:67], v12 offset:53248
    v_mfma_f32_16x16x32_bf16 v[40:43], a[156:159], v[100:103], v[40:43]
    ds_read_b128 v[68:71], v12 offset:54272
    s_waitcnt lgkmcnt(9)
    v_mfma_f32_16x16x32_bf16 v[40:43], a[160:163], v[104:107], v[40:43]
    ds_read_b128 v[72:75], v12 offset:55296
    s_waitcnt lgkmcnt(9)
    v_mfma_f32_16x16x32_bf16 v[40:43], a[164:167], v[108:111], v[40:43]
    ds_read_b128 v[76:79], v12 offset:56320
    v_mfma_f32_16x16x32_bf16 v[44:47], a[156:159], v[108:111], v[44:47]
    ds_read_b128 v[80:83], v12 offset:49168
    s_waitcnt lgkmcnt(10)
    v_mfma_f32_16x16x32_bf16 v[44:47], a[160:163], v[112:115], v[44:47]
    buffer_load_dwordx4 v[228:231], v15, s[44:47], s78 offen offset:1024 sc1
    s_waitcnt lgkmcnt(9)
    v_mfma_f32_16x16x32_bf16 v[44:47], a[164:167], v[116:119], v[44:47]
    s_add_u32 s78, s78, 2048
    s_and_b32 s78, s78, 0x3fff
    buffer_load_dwordx4 v[232:235], v15, s[44:47], s78 offen offset:0 sc1
    s_waitcnt lgkmcnt(8)
    v_mfma_f32_16x16x32_bf16 v[32:35], a[168:171], v[48:51], v[32:35]
    ds_read_b128 v[84:87], v12 offset:57344
    s_waitcnt lgkmcnt(8)
    v_mfma_f32_16x16x32_bf16 v[32:35], a[172:175], v[52:55], v[32:35]
    ds_read_b128 v[88:91], v12 offset:58368
    s_waitcnt lgkmcnt(8)
    v_mfma_f32_16x16x32_bf16 v[32:35], a[176:179], v[56:59], v[32:35]
    ds_read_b128 v[92:95], v12 offset:59392
    v_mfma_f32_16x16x32_bf16 v[36:39], a[168:171], v[56:59], v[36:39]
    ds_read_b128 v[96:99], v12 offset:60416
    s_waitcnt lgkmcnt(9)
    v_mfma_f32_16x16x32_bf16 v[36:39], a[172:175], v[60:63], v[36:39]
    ds_read_b128 v[100:103], v12 offset:61440
    s_waitcnt lgkmcnt(9)
    v_mfma_f32_16x16x32_bf16 v[36:39], a[176:179], v[64:67], v[36:39]
    ds_read_b128 v[104:107], v12 offset:62464
    v_mfma_f32_16x16x32_bf16 v[40:43], a[168:171], v[64:67], v[40:43]
    buffer_load_dwordx4 v[236:239], v15, s[44:47], s78 offen offset:1024 sc1
    s_waitcnt lgkmcnt(9)
    v_mfma_f32_16x16x32_bf16 v[40:43], a[172:175], v[68:71], v[40:43]
    ds_read_b128 v[108:111], v12 offset:63488
    s_waitcnt lgkmcnt(9)
    v_mfma_f32_16x16x32_bf16 v[40:43], a[176:179], v[72:75], v[40:43]
    ds_read_b128 v[112:115], v12 offset:64512
    v_mfma_f32_16x16x32_bf16 v[44:47], a[168:171], v[72:75], v[44:47]
    ds_read_b128 v[116:119], v12 offset:57360
    s_waitcnt lgkmcnt(10)
    v_mfma_f32_16x16x32_bf16 v[44:47], a[172:175], v[76:79], v[44:47]
    s_add_u32 s78, s78, 2048
    s_and_b32 s78, s78, 0x3fff
    buffer_load_dwordx4 v[240:243], v15, s[44:47], s78 offen offset:0 sc1
    s_waitcnt lgkmcnt(9)
    v_mfma_f32_16x16x32_bf16 v[44:47], a[176:179], v[80:83], v[44:47]
    buffer_load_dwordx4 v[244:247], v15, s[44:47], s78 offen offset:1024 sc1
    s_waitcnt lgkmcnt(8)
    v_mfma_f32_16x16x32_bf16 v[32:35], a[180:183], v[84:87], v[32:35]
    s_add_u32 s78, s78, 2048
    s_and_b32 s78, s78, 0x3fff
    buffer_load_dwordx4 v[248:251], v15, s[44:47], s78 offen offset:0 sc1
    s_waitcnt vmcnt(16) lgkmcnt(7)
    v_mfma_f32_16x16x32_bf16 v[32:35], a[184:187], v[88:91], v[32:35]
    s_waitcnt vmcnt(15) lgkmcnt(6)
    v_mfma_f32_16x16x32_bf16 v[32:35], a[188:191], v[92:95], v[32:35]
    v_mfma_f32_16x16x32_bf16 v[36:39], a[180:183], v[92:95], v[36:39]
    buffer_load_dwordx4 v[252:255], v15, s[44:47], s78 offen offset:1024 sc1
    s_waitcnt lgkmcnt(5)
    v_mfma_f32_16x16x32_bf16 v[36:39], a[184:187], v[96:99], v[36:39]
    s_waitcnt lgkmcnt(4)
    v_mfma_f32_16x16x32_bf16 v[36:39], a[188:191], v[100:103], v[36:39]
    v_mfma_f32_16x16x32_bf16 v[40:43], a[180:183], v[100:103], v[40:43]
    s_waitcnt lgkmcnt(3)
    v_mfma_f32_16x16x32_bf16 v[40:43], a[184:187], v[104:107], v[40:43]
    buffer_load_dword v16, v13, s[44:47], s8 offen sc1
    s_waitcnt lgkmcnt(2)
    v_mfma_f32_16x16x32_bf16 v[40:43], a[188:191], v[108:111], v[40:43]
    v_mfma_f32_16x16x32_bf16 v[44:47], a[180:183], v[108:111], v[44:47]
    s_waitcnt lgkmcnt(1)
    v_mfma_f32_16x16x32_bf16 v[44:47], a[184:187], v[112:115], v[44:47]
    s_waitcnt lgkmcnt(0)
    v_mfma_f32_16x16x32_bf16 v[44:47], a[188:191], v[116:119], v[44:47]
    v_pk_mul_f32 v[56:57], v[32:33], v[32:33]
    v_pk_mul_f32 v[58:59], v[34:35], v[34:35]
    v_pk_mul_f32 v[60:61], v[36:37], v[36:37]
    v_pk_mul_f32 v[62:63], v[38:39], v[38:39]
    v_pk_mul_f32 v[64:65], v[40:41], v[40:41]
    v_pk_mul_f32 v[66:67], v[42:43], v[42:43]
    s_nop 1
    v_pk_mul_f32 v[68:69], v[44:45], v[44:45]
    v_pk_mul_f32 v[70:71], v[46:47], v[46:47]
    v_pk_fma_f32 v[56:57], v[56:57], v[10:11], v[10:11] op_sel:[0,0,1] op_sel_hi:[1,0,1]
    v_pk_fma_f32 v[58:59], v[58:59], v[10:11], v[10:11] op_sel:[0,0,1] op_sel_hi:[1,0,1]
    v_pk_fma_f32 v[60:61], v[60:61], v[10:11], v[10:11] op_sel:[0,0,1] op_sel_hi:[1,0,1]
    v_pk_fma_f32 v[62:63], v[62:63], v[10:11], v[10:11] op_sel:[0,0,1] op_sel_hi:[1,0,1]
    v_pk_fma_f32 v[64:65], v[64:65], v[10:11], v[10:11] op_sel:[0,0,1] op_sel_hi:[1,0,1]
    v_pk_fma_f32 v[66:67], v[66:67], v[10:11], v[10:11] op_sel:[0,0,1] op_sel_hi:[1,0,1]
    v_pk_fma_f32 v[68:69], v[68:69], v[10:11], v[10:11] op_sel:[0,0,1] op_sel_hi:[1,0,1]
    v_pk_fma_f32 v[70:71], v[70:71], v[10:11], v[10:11] op_sel:[0,0,1] op_sel_hi:[1,0,1]
    v_pk_mul_f32 v[56:57], v[56:57], v[32:33]
    v_pk_mul_f32 v[58:59], v[58:59], v[34:35]
    v_pk_mul_f32 v[60:61], v[60:61], v[36:37]
    v_pk_mul_f32 v[62:63], v[62:63], v[38:39]
    v_pk_mul_f32 v[64:65], v[64:65], v[40:41]
    v_pk_mul_f32 v[66:67], v[66:67], v[42:43]
    v_pk_mul_f32 v[68:69], v[68:69], v[44:45]
    v_pk_mul_f32 v[70:71], v[70:71], v[46:47]
    v_exp_f32 v56, v56
    v_exp_f32 v57, v57
    v_exp_f32 v58, v58
    v_exp_f32 v59, v59
    v_exp_f32 v60, v60
    v_exp_f32 v61, v61
    v_exp_f32 v62, v62
    v_exp_f32 v63, v63
    v_exp_f32 v64, v64
    v_exp_f32 v65, v65
    v_exp_f32 v66, v66
    v_exp_f32 v67, v67
    v_exp_f32 v68, v68
    v_exp_f32 v69, v69
    v_exp_f32 v70, v70
    v_exp_f32 v71, v71
    v_pk_add_f32 v[56:57], v[56:57], 1.0 op_sel_hi:[1,0]
    v_pk_add_f32 v[58:59], v[58:59], 1.0 op_sel_hi:[1,0]
    v_pk_add_f32 v[60:61], v[60:61], 1.0 op_sel_hi:[1,0]
    v_pk_add_f32 v[62:63], v[62:63], 1.0 op_sel_hi:[1,0]
    v_pk_add_f32 v[64:65], v[64:65], 1.0 op_sel_hi:[1,0]
    v_pk_add_f32 v[66:67], v[66:67], 1.0 op_sel_hi:[1,0]
    v_pk_add_f32 v[68:69], v[68:69], 1.0 op_sel_hi:[1,0]
    v_pk_add_f32 v[70:71], v[70:71], 1.0 op_sel_hi:[1,0]
    v_rcp_f32 v56, v56
    v_rcp_f32 v57, v57
    v_rcp_f32 v58, v58
    v_rcp_f32 v59, v59
    v_rcp_f32 v60, v60
    v_rcp_f32 v61, v61
    v_rcp_f32 v62, v62
    v_rcp_f32 v63, v63
    v_rcp_f32 v64, v64
    v_rcp_f32 v65, v65
    v_rcp_f32 v66, v66
    v_rcp_f32 v67, v67
    v_rcp_f32 v68, v68
    v_rcp_f32 v69, v69
    v_rcp_f32 v70, v70
    v_rcp_f32 v71, v71
    v_pk_mul_f32 v[32:33], v[32:33], v[56:57]
    v_pk_mul_f32 v[34:35], v[34:35], v[58:59]
    v_pk_mul_f32 v[36:37], v[36:37], v[60:61]
    v_pk_mul_f32 v[38:39], v[38:39], v[62:63]
    v_pk_mul_f32 v[40:41], v[40:41], v[64:65]
    v_pk_mul_f32 v[42:43], v[42:43], v[66:67]
    v_pk_mul_f32 v[44:45], v[44:45], v[68:69]
    v_pk_mul_f32 v[46:47], v[46:47], v[70:71]
    v_cvt_pk_bf16_f32 v120, v32, v33
    v_cvt_pk_bf16_f32 v121, v34, v35
    v_cvt_pk_bf16_f32 v122, v36, v37
    v_cvt_pk_bf16_f32 v123, v38, v39
    v_cvt_pk_bf16_f32 v48, v40, v41
    v_cvt_pk_bf16_f32 v49, v42, v43
    v_cvt_pk_bf16_f32 v50, v44, v45
    v_cvt_pk_bf16_f32 v51, v46, v47
    v_permlane16_swap_b32 v120, v122
    v_permlane16_swap_b32 v121, v123
    buffer_store_dwordx4 v[120:123], v2, s[44:47], s83 offen offset:0 sc1
    v_permlane16_swap_b32 v48, v50
    v_permlane16_swap_b32 v49, v51
    buffer_store_dwordx4 v[48:51], v2, s[44:47], s83 offen offset:1024 sc1
    s_waitcnt vmcnt(2)
    s_mov_b32 s94, 60000
L_gp_17:
    v_cmp_le_u32 vcc, 16, v16
    s_nop 0
    s_cmp_eq_u64 vcc, -1
    s_cbranch_scc1 L_gd_18
    buffer_load_dword v16, v13, s[44:47], s8 offen sc1
    s_waitcnt vmcnt(0)
    s_sub_u32 s94, s94, 1
    s_cmp_lg_u32 s94, 0
    s_cbranch_scc1 L_gp_17
L_gd_18:
    s_and_b32 s7, s2, 7
    s_lshl_b32 s7, s7, 14
    s_lshl_b32 s83, s72, 12
    s_add_u32 s7, s7, s83
    s_add_u32 s7, s7, 13631488
    buffer_load_dwordx4 v[104:107], v2, s[44:47], s7 offen offset:0 sc1
    buffer_load_dwordx4 v[108:111], v2, s[44:47], s7 offen offset:1024 sc1
    buffer_load_dwordx4 v[112:115], v2, s[44:47], s7 offen offset:2048 sc1
    buffer_load_dwordx4 v[116:119], v2, s[44:47], s7 offen offset:3072 sc1
    s_lshl_b32 s97, s19, 13
    buffer_load_dwordx4 a[0:3], v31, s[44:47], s97 offen offset:0 sc1
    buffer_load_dwordx4 a[4:7], v31, s[44:47], s97 offen offset:1024 sc1
    buffer_load_dwordx4 a[8:11], v31, s[44:47], s97 offen offset:2048 sc1
    buffer_load_dwordx4 a[12:15], v31, s[44:47], s97 offen offset:3072 sc1
    s_add_u32 s97, s97, 4096
    s_and_b32 s97, s97, 0xffff
    buffer_load_dwordx4 a[16:19], v31, s[44:47], s97 offen offset:0 sc1
    buffer_load_dwordx4 a[20:23], v31, s[44:47], s97 offen offset:1024 sc1
    v_lshrrev_b32 v5, 3, v1
    v_and_b32 v6, 7, v1
    v_lshlrev_b32 v7, 4, v6
    v_lshl_add_u32 v8, v5, 8, v7
    v_add_u32 v26, 98304, v8
    s_lshl_b32 s82, s72, 1
    s_add_u32 s82, s82, 8
    s_sub_u32 s82, s82, s19
    s_and_b32 s82, s82, 7
    s_lshl_b32 s82, s82, 11
    s_add_u32 s82, s82, 98304
    v_add_u32 v27, s82, v2
    s_lshl_b32 s82, s72, 1
    s_add_u32 s82, s82, 9
    s_sub_u32 s82, s82, s19
    s_and_b32 s82, s82, 7
    s_lshl_b32 s82, s82, 11
    s_add_u32 s82, s82, 98304
    v_add_u32 v23, s82, v2
    v_mov_b32 v24, 0
    v_mov_b32 v5, 2
    v_mov_b32 v6, 0
    s_waitcnt vmcnt(10)
    s_cmp_eq_u32 s21, 2
    s_barrier
    s_cbranch_scc0 L_fl_19
    s_mov_b64 exec, 1
    buffer_store_dword v5, v6, s[44:47], s96 offen
    s_mov_b64 exec, -1
L_fl_19:
    s_cmp_eq_u32 s21, 1
    s_cbranch_scc0 L_fg_20
    s_mov_b64 exec, 1
    buffer_store_dword v5, v6, s[44:47], s96 offen sc1
    s_mov_b64 exec, -1
L_fg_20:
    v_add_u32 v7, s80, v2
    ds_write_b128 v7, v[120:123]
    ds_write_b128 v7, v[48:51] offset:1024
    buffer_load_dwordx4 a[24:27], v31, s[44:47], s97 offen offset:2048 sc1
    buffer_load_dwordx4 a[28:31], v31, s[44:47], s97 offen offset:3072 sc1
    s_add_u32 s97, s97, 4096
    s_and_b32 s97, s97, 0xffff
    buffer_load_dwordx4 a[32:35], v31, s[44:47], s97 offen offset:0 sc1
    buffer_load_dwordx4 a[36:39], v31, s[44:47], s97 offen offset:1024 sc1
    s_waitcnt vmcnt(13)
    v_max3_f32 v24, abs(v104), abs(v105), v24
    v_max3_f32 v24, abs(v106), abs(v107), v24
    v_exp_f32 v104, v104
    v_exp_f32 v105, v105
    v_exp_f32 v106, v106
    v_exp_f32 v107, v107
    s_nop 0
    ds_write_b128 v27, v[104:107] offset:0
    s_waitcnt vmcnt(12)
    v_max3_f32 v24, abs(v108), abs(v109), v24
    v_max3_f32 v24, abs(v110), abs(v111), v24
    v_exp_f32 v108, v108
    v_exp_f32 v109, v109
    v_exp_f32 v110, v110
    v_exp_f32 v111, v111
    s_nop 0
    ds_write_b128 v27, v[108:111] offset:1024
    s_waitcnt vmcnt(11)
    v_max3_f32 v24, abs(v112), abs(v113), v24
    v_max3_f32 v24, abs(v114), abs(v115), v24
    v_exp_f32 v112, v112
    v_exp_f32 v113, v113
    v_exp_f32 v114, v114
    v_exp_f32 v115, v115
    s_nop 0
    ds_write_b128 v23, v[112:115] offset:0
    s_waitcnt vmcnt(10)
    v_max3_f32 v24, abs(v116), abs(v117), v24
    v_max3_f32 v24, abs(v118), abs(v119), v24
    v_exp_f32 v116, v116
    v_exp_f32 v117, v117
    v_exp_f32 v118, v118
    v_exp_f32 v119, v119
    s_nop 0
    ds_write_b128 v23, v[116:119] offset:1024
    v_mov_b32 v7, 82176
    v_mov_b32 v8, 0
    ds_write_b32 v7, v8
    s_waitcnt lgkmcnt(0)
    v_lshrrev_b32 v5, 1, v4
    v_lshlrev_b32 v5, 11, v5
    v_and_b32 v6, 1, v4
    v_lshl_add_u32 v5, v6, 9, v5
    v_lshl_add_u32 v12, v3, 4, v5
    s_lshl_b32 s80, s72, 10
    s_lshl_b32 s82, s73, 16
    s_add_u32 s82, s82, 7340032
    s_add_u32 s82, s82, s80
    v_add_u32 v14, s82, v2
    s_lshl_b32 s77, s16, 12
    v_mov_b32 v10, 0x4038aa3b
    v_mov_b32 v11, -1.0
    s_lshl_b32 s82, s73, 17
    s_lshl_b32 s83, s74, 14
    s_add_u32 s82, s82, s83
    s_lshl_b32 s83, s72, 11
    s_add_u32 s82, s82, s83
    s_add_u32 s82, s82, 9437184
    s_mov_b32 s22, s82
    s_cmp_eq_u32 s72, 1
    s_cbranch_scc0 L_polld_22
    s_mov_b32 s94, 60000
L_poll_21:
    buffer_load_dword v5, v0, s[44:47], s95 offen sc1
    s_waitcnt vmcnt(0)
    v_cmp_le_u32 vcc, 2, v5
    s_nop 0
    s_cmp_eq_u64 vcc, -1
    s_cbranch_scc1 L_polld_22
    s_sub_u32 s94, s94, 1
    s_cmp_lg_u32 s94, 0
    s_cbranch_scc1 L_poll_21
L_polld_22:
    s_barrier
    s_add_u32 s77, s77, 4096
    s_and_b32 s77, s77, 0xffff
    s_add_u32 s77, s77, 4096
    s_add_u32 m0, s80, 8192
    s_and_b32 s77, s77, 0xffff
    buffer_load_dwordx4 v14, s[44:47], s77 offen sc1 lds
    s_add_u32 s77, s77, 4096
    s_add_u32 m0, s80, 12288
    s_and_b32 s77, s77, 0xffff
    buffer_load_dwordx4 v14, s[44:47], s77 offen sc1 lds
    s_add_u32 s77, s77, 4096
    s_add_u32 m0, s80, 16384
    s_and_b32 s77, s77, 0xffff
    buffer_load_dwordx4 v14, s[44:47], s77 offen sc1 lds
    s_add_u32 s77, s77, 4096
    s_add_u32 m0, s80, 20480
    s_and_b32 s77, s77, 0xffff
    buffer_load_dwordx4 v14, s[44:47], s77 offen sc1 lds
    s_add_u32 s77, s77, 4096
    s_add_u32 m0, s80, 24576
    s_and_b32 s77, s77, 0xffff
    buffer_load_dwordx4 v14, s[44:47], s77 offen sc1 lds
    s_add_u32 s77, s77, 4096
    s_add_u32 m0, s80, 28672
    s_and_b32 s77, s77, 0xffff
    buffer_load_dwordx4 v14, s[44:47], s77 offen sc1 lds
    s_add_u32 s77, s77, 4096
    s_add_u32 m0, s80, 32768
    s_and_b32 s77, s77, 0xffff
    buffer_load_dwordx4 v14, s[44:47], s77 offen sc1 lds
    s_add_u32 s77, s77, 4096
    s_add_u32 m0, s80, 36864
    s_and_b32 s77, s77, 0xffff
    buffer_load_dwordx4 v14, s[44:47], s77 offen sc1 lds
    s_add_u32 s77, s77, 4096
    s_add_u32 m0, s80, 40960
    s_and_b32 s77, s77, 0xffff
    buffer_load_dwordx4 v14, s[44:47], s77 offen sc1 lds
    ds_read_b128 v[48:51], v12 offset:0
    ds_read_b128 v[52:55], v12 offset:256
    ds_read_b128 v[56:59], v12 offset:1024
    ds_read_b128 v[60:63], v12 offset:1280
    ds_read_b128 v[64:67], v12 offset:4096
    ds_read_b128 v[68:71], v12 offset:4352
    ds_read_b128 v[72:75], v12 offset:5120
    ds_read_b128 v[76:79], v12 offset:5376
    s_waitcnt lgkmcnt(7)
    v_mfma_f32_16x16x32_bf16 v[32:35], v[192:195], v[48:51], 0
    s_add_u32 s77, s77, 4096
    s_add_u32 m0, s80, 45056
    s_and_b32 s77, s77, 0xffff
    buffer_load_dwordx4 v14, s[44:47], s77 offen sc1 lds
    s_waitcnt vmcnt(8)
    s_barrier
    ds_read_b128 v[80:83], v12 offset:8192
    s_waitcnt lgkmcnt(7)
    v_mfma_f32_16x16x32_bf16 v[36:39], v[192:195], v[52:55], 0
    ds_read_b128 v[84:87], v12 offset:8448
    s_waitcnt lgkmcnt(7)
    v_mfma_f32_16x16x32_bf16 v[40:43], v[192:195], v[56:59], 0
    s_add_u32 s77, s77, 4096
    s_add_u32 m0, s80, 49152
    s_and_b32 s77, s77, 0xffff
    buffer_load_dwordx4 v14, s[44:47], s77 offen sc1 lds
    ds_read_b128 v[88:91], v12 offset:9216
    s_waitcnt lgkmcnt(7)
    v_mfma_f32_16x16x32_bf16 v[44:47], v[192:195], v[60:63], 0
    ds_read_b128 v[92:95], v12 offset:9472
    s_waitcnt lgkmcnt(4)
    v_mfma_f32_16x16x32_bf16 v[32:35], v[196:199], v[64:67], v[32:35]
    ds_read_b128 v[48:51], v12 offset:12288
    s_add_u32 s77, s77, 4096
    s_add_u32 m0, s80, 53248
    s_and_b32 s77, s77, 0xffff
    buffer_load_dwordx4 v14, s[44:47], s77 offen sc1 lds
    v_mfma_f32_16x16x32_bf16 v[36:39], v[196:199], v[68:71], v[36:39]
    ds_read_b128 v[52:55], v12 offset:12544
    v_mfma_f32_16x16x32_bf16 v[40:43], v[196:199], v[72:75], v[40:43]
    ds_read_b128 v[56:59], v12 offset:13312
    v_mfma_f32_16x16x32_bf16 v[44:47], v[196:199], v[76:79], v[44:47]
    s_add_u32 s77, s77, 4096
    s_add_u32 m0, s80, 57344
    s_and_b32 s77, s77, 0xffff
    buffer_load_dwordx4 v14, s[44:47], s77 offen sc1 lds
    ds_read_b128 v[60:63], v12 offset:13568
    s_waitcnt lgkmcnt(4)
    v_mfma_f32_16x16x32_bf16 v[32:35], v[200:203], v[80:83], v[32:35]
    s_waitcnt vmcnt(9)
    s_barrier
    ds_read_b128 v[64:67], v12 offset:16384
    v_mfma_f32_16x16x32_bf16 v[36:39], v[200:203], v[84:87], v[36:39]
    s_add_u32 s77, s77, 4096
    s_add_u32 m0, s80, 61440
    s_and_b32 s77, s77, 0xffff
    buffer_load_dwordx4 v14, s[44:47], s77 offen sc1 lds
    ds_read_b128 v[68:71], v12 offset:16640
    v_mfma_f32_16x16x32_bf16 v[40:43], v[200:203], v[88:91], v[40:43]
    ds_read_b128 v[72:75], v12 offset:17408
    v_mfma_f32_16x16x32_bf16 v[44:47], v[200:203], v[92:95], v[44:47]
    ds_read_b128 v[76:79], v12 offset:17664
    s_waitcnt lgkmcnt(4)
    v_mfma_f32_16x16x32_bf16 v[32:35], v[204:207], v[48:51], v[32:35]
    ds_read_b128 v[80:83], v12 offset:20480
    v_mfma_f32_16x16x32_bf16 v[36:39], v[204:207], v[52:55], v[36:39]
    ds_read_b128 v[84:87], v12 offset:20736
    v_mfma_f32_16x16x32_bf16 v[40:43], v[204:207], v[56:59], v[40:43]
    ds_read_b128 v[88:91], v12 offset:21504
    v_mfma_f32_16x16x32_bf16 v[44:47], v[204:207], v[60:63], v[44:47]
    ds_read_b128 v[92:95], v12 offset:21760
    s_waitcnt lgkmcnt(4)
    v_mfma_f32_16x16x32_bf16 v[32:35], v[208:211], v[64:67], v[32:35]
    s_waitcnt vmcnt(8)
    s_barrier
    ds_read_b128 v[48:51], v12 offset:24576
    v_mfma_f32_16x16x32_bf16 v[36:39], v[208:211], v[68:71], v[36:39]
    ds_read_b128 v[52:55], v12 offset:24832
    v_mfma_f32_16x16x32_bf16 v[40:43], v[208:211], v[72:75], v[40:43]
    ds_read_b128 v[56:59], v12 offset:25600
    v_mfma_f32_16x16x32_bf16 v[44:47], v[208:211], v[76:79], v[44:47]
    ds_read_b128 v[60:63], v12 offset:25856
    buffer_load_dwordx4 a[40:43], v31, s[44:47], s97 offen offset:2048 sc1
    s_waitcnt lgkmcnt(4)
    v_mfma_f32_16x16x32_bf16 v[32:35], v[212:215], v[80:83], v[32:35]
    ds_read_b128 v[64:67], v12 offset:28672
    v_mfma_f32_16x16x32_bf16 v[36:39], v[212:215], v[84:87], v[36:39]
    ds_read_b128 v[68:71], v12 offset:28928
    v_mfma_f32_16x16x32_bf16 v[40:43], v[212:215], v[88:91], v[40:43]
    ds_read_b128 v[72:75], v12 offset:29696
    v_mfma_f32_16x16x32_bf16 v[44:47], v[212:215], v[92:95], v[44:47]
    ds_read_b128 v[76:79], v12 offset:29952
    buffer_load_dwordx4 a[44:47], v31, s[44:47], s97 offen offset:3072 sc1
    s_waitcnt lgkmcnt(4)
    v_mfma_f32_16x16x32_bf16 v[32:35], v[216:219], v[48:51], v[32:35]
    s_waitcnt vmcnt(8)
    s_barrier
    ds_read_b128 v[80:83], v12 offset:32768
    v_mfma_f32_16x16x32_bf16 v[36:39], v[216:219], v[52:55], v[36:39]
    ds_read_b128 v[84:87], v12 offset:33024
    v_mfma_f32_16x16x32_bf16 v[40:43], v[216:219], v[56:59], v[40:43]
    ds_read_b128 v[88:91], v12 offset:33792
    v_mfma_f32_16x16x32_bf16 v[44:47], v[216:219], v[60:63], v[44:47]
    ds_read_b128 v[92:95], v12 offset:34048
    s_add_u32 s97, s97, 4096
    s_and_b32 s97, s97, 0xffff
    buffer_load_dwordx4 a[48:51], v31, s[44:47], s97 offen offset:0 sc1
    s_waitcnt lgkmcnt(4)
    v_mfma_f32_16x16x32_bf16 v[32:35], v[220:223], v[64:67], v[32:35]
    ds_read_b128 v[48:51], v12 offset:36864
    v_mfma_f32_16x16x32_bf16 v[36:39], v[220:223], v[68:71], v[36:39]
    ds_read_b128 v[52:55], v12 offset:37120
    v_mfma_f32_16x16x32_bf16 v[40:43], v[220:223], v[72:75], v[40:43]
    ds_read_b128 v[56:59], v12 offset:37888
    v_mfma_f32_16x16x32_bf16 v[44:47], v[220:223], v[76:79], v[44:47]
    ds_read_b128 v[60:63], v12 offset:38144
    buffer_load_dwordx4 a[52:55], v31, s[44:47], s97 offen offset:1024 sc1
    s_waitcnt lgkmcnt(4)
    v_mfma_f32_16x16x32_bf16 v[32:35], v[224:227], v[80:83], v[32:35]
    s_waitcnt vmcnt(8)
    s_barrier
    ds_read_b128 v[64:67], v12 offset:40960
    v_mfma_f32_16x16x32_bf16 v[36:39], v[224:227], v[84:87], v[36:39]
    ds_read_b128 v[68:71], v12 offset:41216
    v_mfma_f32_16x16x32_bf16 v[40:43], v[224:227], v[88:91], v[40:43]
    ds_read_b128 v[72:75], v12 offset:41984
    v_mfma_f32_16x16x32_bf16 v[44:47], v[224:227], v[92:95], v[44:47]
    ds_read_b128 v[76:79], v12 offset:42240
    buffer_load_dwordx4 a[56:59], v31, s[44:47], s97 offen offset:2048 sc1
    s_waitcnt lgkmcnt(4)
    v_mfma_f32_16x16x32_bf16 v[32:35], v[228:231], v[48:51], v[32:35]
    ds_read_b128 v[80:83], v12 offset:45056
    v_mfma_f32_16x16x32_bf16 v[36:39], v[228:231], v[52:55], v[36:39]
    ds_read_b128 v[84:87], v12 offset:45312
    v_mfma_f32_16x16x32_bf16 v[40:43], v[228:231], v[56:59], v[40:43]
    ds_read_b128 v[88:91], v12 offset:46080
    s_nop 0
    s_nop 0
L_PAD4:
    s_cbranch_execz L_PADRET
    v_mfma_f32_16x16x32_bf16 v[44:47], v[228:231], v[60:63], v[44:47]
    ds_read_b128 v[92:95], v12 offset:46336
    buffer_load_dwordx4 a[60:63], v31, s[44:47], s97 offen offset:3072 sc1
    s_waitcnt lgkmcnt(4)
    v_mfma_f32_16x16x32_bf16 v[32:35], v[232:235], v[64:67], v[32:35]
    s_waitcnt vmcnt(8)
    s_barrier
    ds_read_b128 v[48:51], v12 offset:49152
    v_mfma_f32_16x16x32_bf16 v[36:39], v[232:235], v[68:71], v[36:39]
    ds_read_b128 v[52:55], v12 offset:49408
    v_mfma_f32_16x16x32_bf16 v[40:43], v[232:235], v[72:75], v[40:43]
    ds_read_b128 v[56:59], v12 offset:50176
    v_mfma_f32_16x16x32_bf16 v[44:47], v[232:235], v[76:79], v[44:47]
    ds_read_b128 v[60:63], v12 offset:50432
    s_add_u32 s97, s97, 4096
    s_and_b32 s97, s97, 0xffff
    buffer_load_dwordx4 a[64:67], v31, s[44:47], s97 offen offset:0 sc1
    s_waitcnt lgkmcnt(4)
    v_mfma_f32_16x16x32_bf16 v[32:35], v[236:239], v[80:83], v[32:35]
    ds_read_b128 v[64:67], v12 offset:53248
    v_mfma_f32_16x16x32_bf16 v[36:39], v[236:239], v[84:87], v[36:39]
    ds_read_b128 v[68:71], v12 offset:53504
    v_mfma_f32_16x16x32_bf16 v[40:43], v[236:239], v[88:91], v[40:43]
    ds_read_b128 v[72:75], v12 offset:54272
    v_mfma_f32_16x16x32_bf16 v[44:47], v[236:239], v[92:95], v[44:47]
    ds_read_b128 v[76:79], v12 offset:54528
    buffer_load_dwordx4 a[68:71], v31, s[44:47], s97 offen offset:1024 sc1
    s_waitcnt lgkmcnt(4)
    v_mfma_f32_16x16x32_bf16 v[32:35], v[240:243], v[48:51], v[32:35]
    s_waitcnt vmcnt(8)
    s_barrier
    ds_read_b128 v[80:83], v12 offset:57344
    v_mfma_f32_16x16x32_bf16 v[36:39], v[240:243], v[52:55], v[36:39]
    ds_read_b128 v[84:87], v12 offset:57600
    v_mfma_f32_16x16x32_bf16 v[40:43], v[240:243], v[56:59], v[40:43]
    ds_read_b128 v[88:91], v12 offset:58368
    v_mfma_f32_16x16x32_bf16 v[44:47], v[240:243], v[60:63], v[44:47]
    ds_read_b128 v[92:95], v12 offset:58624
    buffer_load_dwordx4 a[72:75], v31, s[44:47], s97 offen offset:2048 sc1
    s_waitcnt lgkmcnt(4)
    v_mfma_f32_16x16x32_bf16 v[32:35], v[244:247], v[64:67], v[32:35]
    ds_read_b128 v[48:51], v12 offset:61440
    v_mfma_f32_16x16x32_bf16 v[36:39], v[244:247], v[68:71], v[36:39]
    ds_read_b128 v[52:55], v12 offset:61696
    v_mfma_f32_16x16x32_bf16 v[40:43], v[244:247], v[72:75], v[40:43]
    ds_read_b128 v[56:59], v12 offset:62464
    v_mfma_f32_16x16x32_bf16 v[44:47], v[244:247], v[76:79], v[44:47]
    ds_read_b128 v[60:63], v12 offset:62720
    buffer_load_dwordx4 a[76:79], v31, s[44:47], s97 offen offset:3072 sc1
    s_waitcnt lgkmcnt(4)
    v_mfma_f32_16x16x32_bf16 v[32:35], v[248:251], v[80:83], v[32:35]
    v_mfma_f32_16x16x32_bf16 v[36:39], v[248:251], v[84:87], v[36:39]
    v_mfma_f32_16x16x32_bf16 v[40:43], v[248:251], v[88:91], v[40:43]
    v_mfma_f32_16x16x32_bf16 v[44:47], v[248:251], v[92:95], v[44:47]
    s_waitcnt lgkmcnt(0)
    v_mfma_f32_16x16x32_bf16 v[32:35], v[252:255], v[48:51], v[32:35]
    v_mfma_f32_16x16x32_bf16 v[36:39], v[252:255], v[52:55], v[36:39]
    v_mfma_f32_16x16x32_bf16 v[40:43], v[252:255], v[56:59], v[40:43]
    v_mfma_f32_16x16x32_bf16 v[44:47], v[252:255], v[60:63], v[44:47]
    s_nop 4
    v_cvt_pk_bf16_f32 v48, v32, v33
    v_cvt_pk_bf16_f32 v49, v34, v35
    v_cvt_pk_bf16_f32 v50, v36, v37
    v_cvt_pk_bf16_f32 v51, v38, v39
    v_cvt_pk_bf16_f32 v52, v40, v41
    v_cvt_pk_bf16_f32 v53, v42, v43
    v_cvt_pk_bf16_f32 v54, v44, v45
    v_cvt_pk_bf16_f32 v55, v46, v47
    v_permlane16_swap_b32 v48, v50
    v_permlane16_swap_b32 v49, v51
    v_permlane16_swap_b32 v52, v54
    v_permlane16_swap_b32 v53, v55
    buffer_store_dwordx4 v[48:51], v2, s[44:47], s82 offen offset:0 sc1
    buffer_store_dwordx4 v[52:55], v2, s[44:47], s82 offen offset:1024 sc1
    s_add_u32 s97, s97, 4096
    s_and_b32 s97, s97, 0xffff
    buffer_load_dwordx4 a[80:83], v31, s[44:47], s97 offen offset:0 sc1
    buffer_load_dwordx4 a[84:87], v31, s[44:47], s97 offen offset:1024 sc1
    buffer_load_dwordx4 a[88:91], v31, s[44:47], s97 offen offset:2048 sc1
    buffer_load_dwordx4 a[92:95], v31, s[44:47], s97 offen offset:3072 sc1
    s_add_u32 s97, s97, 4096
    s_and_b32 s97, s97, 0xffff
    buffer_load_dwordx4 a[96:99], v31, s[44:47], s97 offen offset:0 sc1
    ds_read_b128 v[128:131], v26 offset:0
    ds_read_b128 v[132:135], v26 offset:128
    ds_read_b128 v[136:139], v26 offset:2048
    ds_read_b128 v[140:143], v26 offset:2176
    ds_read_b128 v[144:147], v26 offset:4096
    ds_read_b128 v[148:151], v26 offset:4224
    ds_read_b128 v[152:155], v26 offset:6144
    ds_read_b128 v[156:159], v26 offset:6272
    ds_read_b128 v[160:163], v26 offset:8192
    ds_read_b128 v[164:167], v26 offset:8320
    ds_read_b128 v[168:171], v26 offset:10240
    ds_read_b128 v[172:175], v26 offset:10368
    ds_read_b128 v[176:179], v26 offset:12288
    ds_read_b128 v[180:183], v26 offset:12416
    ds_read_b128 v[184:187], v26 offset:14336
    ds_read_b128 v[188:191], v26 offset:14464
    v_lshrrev_b32 v5, 3, v1
    v_and_b32 v6, 7, v1
    s_mul_i32 s82, s72, 4128
    s_add_u32 s82, s82, 65536
    v_lshlrev_b32 v7, 5, v5
    v_add_u32 v12, s82, v7
    v_lshlrev_b32 v7, 4, v6
    v_lshl_add_u32 v8, v5, 10, v7
    s_lshl_b32 s82, s72, 8
    v_add_u32 v13, s82, v8
    v_and_b32 v8, 3, v5
    v_lshl_add_u32 v7, v8, 8, v7
    v_lshrrev_b32 v8, 2, v5
    v_lshl_add_u32 v15, v8, 12, v7
    v_mul_u32_u24 v7, 2064, v6
    v_lshl_add_u32 v7, v5, 4, v7
    s_lshl_b32 s82, s72, 1
    s_add_u32 s82, s82, 8
    s_sub_u32 s82, s82, s19
    s_and_b32 s82, s82, 7
    s_lshl_b32 s82, s82, 8
    s_add_u32 s82, s82, 65536
    v_add_u32 v14, s82, v7
    s_lshl_b32 s82, s72, 1
    s_add_u32 s82, s82, 9
    s_sub_u32 s82, s82, s19
    s_and_b32 s82, s82, 7
    s_lshl_b32 s82, s82, 8
    s_add_u32 s82, s82, 65536
    v_add_u32 v20, s82, v7
    v_lshlrev_b32 v7, 4, v3
    v_lshl_add_u32 v25, v4, 10, v7
    s_lshr_b32 s82, s74, 2
    s_lshl_b32 s82, s82, 5
    s_and_b32 s83, s74, 3
    s_add_u32 s82, s82, s83
    s_mul_i32 s83, s76, 63
    s_add_u32 s84, s83, s82
    s_lshl_b32 s84, s84, 13
    v_lshrrev_b32 v5, 3, v3
    v_lshlrev_b32 v7, 15, v5
    v_lshl_add_u32 v7, v6, 10, v7
    v_lshl_add_u32 v7, v4, 4, v7
    s_lshl_b32 s82, s72, 6
    s_add_u32 s84, s84, s82
    v_add_u32 v17, s84, v7
    v_add_u32 v16, s82, v17
    s_mov_b32 s100, 65536
    s_mov_b32 s101, 131072
    s_mov_b32 s6, 196608
    s_cmp_eq_u32 s74, 7
    s_cselect_b32 s82, 1, 2
    v_cmp_eq_u32 vcc, s82, v5
    v_mov_b32 v8, 0x7ff00000
    s_nop 0
    v_cndmask_b32 v18, v16, v8, vcc
    v_cndmask_b32 v19, v17, v8, vcc
    s_bfe_u32 s82, s28, 0x1000f
    s_lshl_b32 s82, s82, 8
    v_add_u32 v21, s82, v17
    v_add_u32 v22, s82, v19
    s_xor_b32 s82, s82, 256
    v_add_u32 v17, s82, v17
    v_add_u32 v19, s82, v19
    v_and_b32 v5, 31, v1
    v_lshrrev_b32 v6, 5, v1
    v_lshlrev_b32 v7, 4, v5
    v_lshl_add_u32 v28, v6, 10, v7
    v_lshrrev_b32 v5, 3, v1
    v_and_b32 v6, 7, v1
    v_lshrrev_b32 v7, 1, v5
    v_lshlrev_b32 v7, 11, v7
    v_and_b32 v8, 1, v5
    v_lshl_add_u32 v7, v8, 9, v7
    v_lshl_add_u32 v15, v6, 4, v7
    v_lshl_add_u32 v14, v5, 4, v14
    v_lshl_add_u32 v20, v5, 4, v20
    s_lshl_b32 s82, s73, 17
    s_bfe_u32 s83, s74, 0x10001
    s_lshl_b32 s83, s83, 10
    s_add_u32 s82, s82, s83
    s_and_b32 s83, s74, 1
    s_lshl_b32 s83, s83, 8
    s_add_u32 s82, s82, s83
    s_lshr_b32 s83, s74, 2
    s_lshl_b32 s83, s83, 7
    s_add_u32 s82, s82, s83
    s_lshl_b32 s83, s72, 15
    s_add_u32 s82, s82, s83
    s_add_u32 s8, s82, 9437184
    s_add_u32 s85, s8, 16384
    v_mov_b32 v5, 4
    v_mov_b32 v6, 0
    s_waitcnt vmcnt(5)
    s_cmp_eq_u32 s21, 2
    s_barrier
    s_cbranch_scc0 L_fl_23
    s_mov_b64 exec, 1
    buffer_store_dword v5, v6, s[44:47], s96 offen
    s_mov_b64 exec, -1
L_fl_23:
    s_cmp_eq_u32 s21, 1
    s_cbranch_scc0 L_fg_24
    s_mov_b64 exec, 1
    buffer_store_dword v5, v6, s[44:47], s96 offen sc1
    s_mov_b64 exec, -1
L_fg_24:
    buffer_load_dwordx4 a[100:103], v31, s[44:47], s97 offen offset:1024 sc1
    buffer_load_dwordx4 a[104:107], v31, s[44:47], s97 offen offset:2048 sc1
    buffer_load_dwordx4 a[108:111], v31, s[44:47], s97 offen offset:3072 sc1
    s_add_u32 s97, s97, 4096
    s_and_b32 s97, s97, 0xffff
    buffer_load_dwordx4 a[112:115], v31, s[44:47], s97 offen offset:0 sc1
    buffer_load_dwordx4 a[116:119], v31, s[44:47], s97 offen offset:1024 sc1
    buffer_load_dwordx4 a[120:123], v31, s[44:47], s97 offen offset:2048 sc1
    s_cmp_eq_u32 s72, 1
    s_cbranch_scc0 L_polld_26
    s_mov_b32 s94, 60000
L_poll_25:
    buffer_load_dword v5, v0, s[44:47], s95 offen sc1
    s_waitcnt vmcnt(0)
    v_cmp_le_u32 vcc, 4, v5
    s_nop 0
    s_cmp_eq_u64 vcc, -1
    s_cbranch_scc1 L_polld_26
    s_sub_u32 s94, s94, 1
    s_cmp_lg_u32 s94, 0
    s_cbranch_scc1 L_poll_25
L_polld_26:
    s_barrier
    buffer_load_dwordx4 v[104:107], v15, s[44:47], s8 offen sc1
    buffer_load_dwordx4 v[108:111], v15, s[44:47], s85 offen sc1
    buffer_load_dwordx4 a[124:127], v31, s[44:47], s97 offen offset:3072 sc1
    s_add_u32 s97, s97, 4096
    s_and_b32 s97, s97, 0xffff
    buffer_load_dwordx4 a[128:131], v31, s[44:47], s97 offen offset:0 sc1
    buffer_load_dwordx4 a[132:135], v31, s[44:47], s97 offen offset:1024 sc1
    buffer_load_dwordx4 a[136:139], v31, s[44:47], s97 offen offset:2048 sc1
    buffer_load_dwordx4 a[140:143], v31, s[44:47], s97 offen offset:3072 sc1
    s_add_u32 s97, s97, 4096
    s_and_b32 s97, s97, 0xffff
    buffer_load_dwordx4 a[144:147], v31, s[44:47], s97 offen offset:0 sc1
    buffer_load_dwordx4 a[148:151], v31, s[44:47], s97 offen offset:1024 sc1
    buffer_load_dwordx4 a[152:155], v31, s[44:47], s97 offen offset:2048 sc1
    buffer_load_dwordx4 a[156:159], v31, s[44:47], s97 offen offset:3072 sc1
    s_add_u32 s97, s97, 4096
    s_and_b32 s97, s97, 0xffff
    buffer_load_dwordx4 a[160:163], v31, s[44:47], s97 offen offset:0 sc1
    buffer_load_dwordx4 a[164:167], v31, s[44:47], s97 offen offset:1024 sc1
    buffer_load_dwordx4 a[168:171], v31, s[44:47], s97 offen offset:2048 sc1
    s_waitcnt vmcnt(13)
    v_lshlrev_b32 v208, 16, v104
    v_and_b32 v209, 0xffff0000, v104
    v_lshlrev_b32 v210, 16, v105
    v_and_b32 v211, 0xffff0000, v105
    v_lshlrev_b32 v212, 16, v106
    v_and_b32 v213, 0xffff0000, v106
    v_lshlrev_b32 v214, 16, v107
    v_and_b32 v215, 0xffff0000, v107
    v_pk_fma_f32 v[208:209], v[208:209], v[10:11], v[10:11] op_sel:[0,0,1] op_sel_hi:[1,0,1]
    v_pk_fma_f32 v[210:211], v[210:211], v[10:11], v[10:11] op_sel:[0,0,1] op_sel_hi:[1,0,1]
    v_pk_fma_f32 v[212:213], v[212:213], v[10:11], v[10:11] op_sel:[0,0,1] op_sel_hi:[1,0,1]
    v_pk_fma_f32 v[214:215], v[214:215], v[10:11], v[10:11] op_sel:[0,0,1] op_sel_hi:[1,0,1]
    v_max3_f32 v24, abs(v208), abs(v209), v24
    v_max3_f32 v24, abs(v210), abs(v211), v24
    v_max3_f32 v24, abs(v212), abs(v213), v24
    v_max3_f32 v24, abs(v214), abs(v215), v24
    v_exp_f32 v208, v208
    v_exp_f32 v209, v209
    v_exp_f32 v210, v210
    v_exp_f32 v211, v211
    v_exp_f32 v212, v212
    v_exp_f32 v213, v213
    v_exp_f32 v214, v214
    v_exp_f32 v215, v215
    s_nop 0
    ds_write_b128 v14, v[208:211] offset:0
    ds_write_b128 v14, v[212:215] offset:16
    s_waitcnt vmcnt(12)
    v_lshlrev_b32 v216, 16, v108
    v_and_b32 v217, 0xffff0000, v108
    v_lshlrev_b32 v218, 16, v109
    v_and_b32 v219, 0xffff0000, v109
    v_lshlrev_b32 v220, 16, v110
    v_and_b32 v221, 0xffff0000, v110
    v_lshlrev_b32 v222, 16, v111
    v_and_b32 v223, 0xffff0000, v111
    v_pk_fma_f32 v[216:217], v[216:217], v[10:11], v[10:11] op_sel:[0,0,1] op_sel_hi:[1,0,1]
    v_pk_fma_f32 v[218:219], v[218:219], v[10:11], v[10:11] op_sel:[0,0,1] op_sel_hi:[1,0,1]
    v_pk_fma_f32 v[220:221], v[220:221], v[10:11], v[10:11] op_sel:[0,0,1] op_sel_hi:[1,0,1]
    v_pk_fma_f32 v[222:223], v[222:223], v[10:11], v[10:11] op_sel:[0,0,1] op_sel_hi:[1,0,1]
    v_max3_f32 v24, abs(v216), abs(v217), v24
    v_max3_f32 v24, abs(v218), abs(v219), v24
    v_max3_f32 v24, abs(v220), abs(v221), v24
    v_max3_f32 v24, abs(v222), abs(v223), v24
    v_exp_f32 v216, v216
    v_exp_f32 v217, v217
    v_exp_f32 v218, v218
    v_exp_f32 v219, v219
    v_exp_f32 v220, v220
    v_exp_f32 v221, v221
    v_exp_f32 v222, v222
    v_exp_f32 v223, v223
    s_nop 0
    ds_write_b128 v20, v[216:219] offset:0
    ds_write_b128 v20, v[220:223] offset:16
    v_cmp_lt_f32 vcc, 0x42c80000, v24
    s_nop 0
    s_cmp_eq_u64 vcc, 0
    s_cbranch_scc1 L_ok_27
    v_mov_b32 v7, 82176
    v_mov_b32 v8, 1
    ds_write_b32 v7, v8
L_ok_27:
    s_waitcnt lgkmcnt(0)
    s_barrier
    v_mov_b32 v7, 82176
    ds_read_b32 v8, v7
    ds_read_b128 v[224:227], v12 offset:0
    ds_read_b128 v[228:231], v12 offset:16
    ds_read_b128 v[232:235], v12 offset:2064
    ds_read_b128 v[236:239], v12 offset:2080
    s_waitcnt lgkmcnt(4)
    v_readfirstlane_b32 s82, v8
    s_nop 0
    s_cmp_lg_u32 s82, 0
    s_cbranch_scc1 L_SLOW
L_SLOWRET:
    s_waitcnt lgkmcnt(2)
    v_pk_fma_f32 v[224:225], v[224:225], v[128:129], 0.5 op_sel_hi:[1,1,0]
    buffer_load_dwordx4 a[172:175], v31, s[44:47], s97 offen offset:3072 sc1
    v_pk_fma_f32 v[226:227], v[226:227], v[130:131], 0.5 op_sel_hi:[1,1,0]
    v_pk_fma_f32 v[228:229], v[228:229], v[132:133], 0.5 op_sel_hi:[1,1,0]
    v_pk_fma_f32 v[230:231], v[230:231], v[134:135], 0.5 op_sel_hi:[1,1,0]
    s_add_u32 s97, s97, 4096
    s_and_b32 s97, s97, 0xffff
    buffer_load_dwordx4 a[176:179], v31, s[44:47], s97 offen offset:0 sc1
    ds_read_b128 v[240:243], v12 offset:256
    ds_read_b128 v[244:247], v12 offset:272
    v_rcp_f32 v224, v224
    v_rcp_f32 v225, v225
    buffer_load_dwordx4 a[180:183], v31, s[44:47], s97 offen offset:1024 sc1
    v_rcp_f32 v226, v226
    v_rcp_f32 v227, v227
    v_rcp_f32 v228, v228
    v_rcp_f32 v229, v229
    buffer_load_dwordx4 a[184:187], v31, s[44:47], s97 offen offset:2048 sc1
    v_rcp_f32 v230, v230
    v_rcp_f32 v231, v231
    v_pk_add_f32 v[224:225], 1.0, v[224:225] op_sel_hi:[0,1] neg_lo:[0,1] neg_hi:[0,1]
    v_pk_add_f32 v[226:227], 1.0, v[226:227] op_sel_hi:[0,1] neg_lo:[0,1] neg_hi:[0,1]
    buffer_load_dwordx4 a[188:191], v31, s[44:47], s97 offen offset:3072 sc1
    v_pk_add_f32 v[228:229], 1.0, v[228:229] op_sel_hi:[0,1] neg_lo:[0,1] neg_hi:[0,1]
    v_pk_add_f32 v[230:231], 1.0, v[230:231] op_sel_hi:[0,1] neg_lo:[0,1] neg_hi:[0,1]
    v_cvt_pk_bf16_f32 v96, v224, v225
    v_cvt_pk_bf16_f32 v97, v226, v227
    s_add_u32 s97, s97, 4096
    s_and_b32 s97, s97, 0xffff
    buffer_load_dwordx4 a[192:195], v31, s[44:47], s97 offen offset:0 sc1
    v_cvt_pk_bf16_f32 v98, v228, v229
    v_cvt_pk_bf16_f32 v99, v230, v231
    ds_write_b128 v13, v[96:99] offset:0
    ds_read_b128 v[224:227], v12 offset:2320
    buffer_load_dwordx4 a[196:199], v31, s[44:47], s97 offen offset:1024 sc1
    ds_read_b128 v[228:231], v12 offset:2336
    s_waitcnt lgkmcnt(5)
    v_pk_fma_f32 v[232:233], v[232:233], v[128:129], 0.5 op_sel_hi:[1,1,0]
    v_pk_fma_f32 v[234:235], v[234:235], v[130:131], 0.5 op_sel_hi:[1,1,0]
    buffer_load_dwordx4 a[200:203], v31, s[44:47], s97 offen offset:2048 sc1
    v_pk_fma_f32 v[236:237], v[236:237], v[132:133], 0.5 op_sel_hi:[1,1,0]
    v_pk_fma_f32 v[238:239], v[238:239], v[134:135], 0.5 op_sel_hi:[1,1,0]
    v_rcp_f32 v232, v232
    v_rcp_f32 v233, v233
    buffer_load_dwordx4 a[204:207], v31, s[44:47], s97 offen offset:3072 sc1
    v_rcp_f32 v234, v234
    v_rcp_f32 v235, v235
    v_rcp_f32 v236, v236
    v_rcp_f32 v237, v237
    s_add_u32 s97, s97, 4096
    s_and_b32 s97, s97, 0xffff
    buffer_load_dwordx4 a[208:211], v31, s[44:47], s97 offen offset:0 sc1
    v_rcp_f32 v238, v238
    v_rcp_f32 v239, v239
    v_pk_add_f32 v[232:233], 1.0, v[232:233] op_sel_hi:[0,1] neg_lo:[0,1] neg_hi:[0,1]
    v_pk_add_f32 v[234:235], 1.0, v[234:235] op_sel_hi:[0,1] neg_lo:[0,1] neg_hi:[0,1]
    buffer_load_dwordx4 a[212:215], v31, s[44:47], s97 offen offset:1024 sc1
    v_pk_add_f32 v[236:237], 1.0, v[236:237] op_sel_hi:[0,1] neg_lo:[0,1] neg_hi:[0,1]
    v_pk_add_f32 v[238:239], 1.0, v[238:239] op_sel_hi:[0,1] neg_lo:[0,1] neg_hi:[0,1]
    v_cvt_pk_bf16_f32 v100, v232, v233
    v_cvt_pk_bf16_f32 v101, v234, v235
    buffer_load_dwordx4 a[216:219], v31, s[44:47], s97 offen offset:2048 sc1
    v_cvt_pk_bf16_f32 v102, v236, v237
    v_cvt_pk_bf16_f32 v103, v238, v239
    ds_write_b128 v13, v[100:103] offset:128
    s_waitcnt lgkmcnt(0)
    s_barrier
    ds_read_b128 v[192:195], v28 offset:0
    ds_read_b128 v[196:199], v28 offset:512
    ds_read_b128 v[200:203], v28 offset:2048
    ds_read_b128 v[204:207], v28 offset:2560
    s_waitcnt lgkmcnt(3)
    v_mfma_f32_32x32x16_bf16 v[32:47], a[0:3], v[192:195], 0
    buffer_load_dwordx4 a[220:223], v31, s[44:47], s97 offen offset:3072 sc1
    v_fma_f32 v240, v240, v136, 0.5
    v_fma_f32 v241, v241, v137, 0.5
    v_rcp_f32 v240, v240
    v_fma_f32 v242, v242, v138, 0.5
    v_rcp_f32 v241, v241
    v_sub_f32 v240, 1.0, v240
    s_waitcnt lgkmcnt(2)
    v_mfma_f32_32x32x16_bf16 v[48:63], a[0:3], v[196:199], 0
    s_add_u32 s97, s97, 4096
    s_and_b32 s97, s97, 0xffff
    buffer_load_dwordx4 a[224:227], v31, s[44:47], s97 offen offset:0 sc1
    v_fma_f32 v243, v243, v139, 0.5
    v_rcp_f32 v242, v242
    v_sub_f32 v241, 1.0, v241
    v_fma_f32 v244, v244, v140, 0.5
    v_rcp_f32 v243, v243
    v_sub_f32 v242, 1.0, v242
    v_cvt_pk_bf16_f32 v96, v240, v241
    v_mfma_f32_32x32x16_bf16 v[80:95], a[4:7], v[196:199], 0
    ds_read_b128 v[208:211], v28 offset:4096
    v_fma_f32 v245, v245, v141, 0.5
    v_rcp_f32 v244, v244
    v_sub_f32 v243, 1.0, v243
    v_fma_f32 v246, v246, v142, 0.5
    v_rcp_f32 v245, v245
    v_sub_f32 v244, 1.0, v244
    v_cvt_pk_bf16_f32 v97, v242, v243
    v_fma_f32 v247, v247, v143, 0.5
    v_rcp_f32 v246, v246
    v_sub_f32 v245, 1.0, v245
    v_mfma_f32_32x32x16_bf16 v[64:79], a[4:7], v[192:195], 0
    ds_read_b128 v[212:215], v28 offset:4608
    v_fma_f32 v224, v224, v136, 0.5
    v_rcp_f32 v247, v247
    v_sub_f32 v246, 1.0, v246
    v_cvt_pk_bf16_f32 v98, v244, v245
    v_fma_f32 v225, v225, v137, 0.5
    v_rcp_f32 v224, v224
    v_sub_f32 v247, 1.0, v247
    s_waitcnt lgkmcnt(3)
    v_mfma_f32_32x32x16_bf16 v[32:47], a[8:11], v[200:203], v[32:47]
    ds_read_b128 v[216:219], v28 offset:6144
    v_fma_f32 v226, v226, v138, 0.5
    v_rcp_f32 v225, v225
    v_sub_f32 v224, 1.0, v224
    v_cvt_pk_bf16_f32 v99, v246, v247
    ds_read_b128 v[232:235], v12 offset:512
    ds_read_b128 v[236:239], v12 offset:528
    v_fma_f32 v227, v227, v139, 0.5
    v_rcp_f32 v226, v226
    v_sub_f32 v225, 1.0, v225
    ds_write_b128 v13, v[96:99] offset:8192
    v_fma_f32 v228, v228, v140, 0.5
    v_rcp_f32 v227, v227
    v_sub_f32 v226, 1.0, v226
    v_cvt_pk_bf16_f32 v100, v224, v225
    s_waitcnt lgkmcnt(6)
    v_mfma_f32_32x32x16_bf16 v[48:63], a[8:11], v[204:207], v[48:63]
    ds_read_b128 v[220:223], v28 offset:6656
    v_fma_f32 v229, v229, v141, 0.5
    v_rcp_f32 v228, v228
    v_sub_f32 v227, 1.0, v227
    v_fma_f32 v230, v230, v142, 0.5
    v_rcp_f32 v229, v229
    v_sub_f32 v228, 1.0, v228
    v_cvt_pk_bf16_f32 v101, v226, v227
    v_mfma_f32_32x32x16_bf16 v[80:95], a[12:15], v[204:207], v[80:95]
    buffer_load_dwordx4 a[228:231], v31, s[44:47], s97 offen offset:1024 sc1
    v_fma_f32 v231, v231, v143, 0.5
    v_rcp_f32 v230, v230
    v_sub_f32 v229, 1.0, v229
    s_waitcnt lgkmcnt(2)
    v_fma_f32 v232, v232, v144, 0.5
    v_rcp_f32 v231, v231
    v_sub_f32 v230, 1.0, v230
    v_cvt_pk_bf16_f32 v102, v228, v229
    v_fma_f32 v233, v233, v145, 0.5
    v_rcp_f32 v232, v232
    v_sub_f32 v231, 1.0, v231
    v_mfma_f32_32x32x16_bf16 v[64:79], a[12:15], v[200:203], v[64:79]
    buffer_load_dwordx4 a[232:235], v31, s[44:47], s97 offen offset:2048 sc1
    v_fma_f32 v234, v234, v146, 0.5
    v_rcp_f32 v233, v233
    v_sub_f32 v232, 1.0, v232
    v_cvt_pk_bf16_f32 v103, v230, v231
    ds_read_b128 v[240:243], v12 offset:2576
    ds_read_b128 v[244:247], v12 offset:2592
    v_fma_f32 v235, v235, v147, 0.5
    v_rcp_f32 v234, v234
    v_sub_f32 v233, 1.0, v233
    ds_write_b128 v13, v[100:103] offset:8320
    v_mfma_f32_32x32x16_bf16 v[32:47], a[16:19], v[208:211], v[32:47]
    buffer_load_dwordx4 a[236:239], v31, s[44:47], s97 offen offset:3072 sc1
    v_fma_f32 v236, v236, v148, 0.5
    v_rcp_f32 v235, v235
    v_sub_f32 v234, 1.0, v234
    v_cvt_pk_bf16_f32 v96, v232, v233
    v_mfma_f32_32x32x16_bf16 v[48:63], a[16:19], v[212:215], v[48:63]
    s_add_u32 s97, s97, 4096
    s_and_b32 s97, s97, 0xffff
    buffer_load_dwordx4 a[240:243], v31, s[44:47], s97 offen offset:0 sc1
    v_fma_f32 v237, v237, v149, 0.5
    v_rcp_f32 v236, v236
    v_sub_f32 v235, 1.0, v235
    v_mfma_f32_32x32x16_bf16 v[80:95], a[20:23], v[212:215], v[80:95]
    s_waitcnt lgkmcnt(0)
    s_barrier
    ds_read_b128 v[192:195], v28 offset:8192
    v_fma_f32 v238, v238, v150, 0.5
    v_rcp_f32 v237, v237
    v_sub_f32 v236, 1.0, v236
    v_cvt_pk_bf16_f32 v97, v234, v235
    v_mfma_f32_32x32x16_bf16 v[64:79], a[20:23], v[208:211], v[64:79]
    ds_read_b128 v[196:199], v28 offset:8704
    v_fma_f32 v239, v239, v151, 0.5
    v_rcp_f32 v238, v238
    v_sub_f32 v237, 1.0, v237
    v_mfma_f32_32x32x16_bf16 v[32:47], a[24:27], v[216:219], v[32:47]
    ds_read_b128 v[200:203], v28 offset:10240
    v_fma_f32 v240, v240, v144, 0.5
    v_rcp_f32 v239, v239
    v_sub_f32 v238, 1.0, v238
    v_cvt_pk_bf16_f32 v98, v236, v237
    v_mfma_f32_32x32x16_bf16 v[48:63], a[24:27], v[220:223], v[48:63]
    ds_read_b128 v[204:207], v28 offset:10752
    ds_read_b128 v[224:227], v12 offset:768
    v_fma_f32 v241, v241, v145, 0.5
    v_rcp_f32 v240, v240
    v_sub_f32 v239, 1.0, v239
    v_mfma_f32_32x32x16_bf16 v[80:95], a[28:31], v[220:223], v[80:95]
    buffer_load_dwordx4 a[244:247], v31, s[44:47], s97 offen offset:1024 sc1
    ds_read_b128 v[228:231], v12 offset:784
    v_fma_f32 v242, v242, v146, 0.5
    v_rcp_f32 v241, v241
    v_sub_f32 v240, 1.0, v240
    v_cvt_pk_bf16_f32 v99, v238, v239
    v_mfma_f32_32x32x16_bf16 v[64:79], a[28:31], v[216:219], v[64:79]
    buffer_load_dwordx4 a[248:251], v31, s[44:47], s97 offen offset:2048 sc1
    v_fma_f32 v243, v243, v147, 0.5
    v_rcp_f32 v242, v242
    v_sub_f32 v241, 1.0, v241
    ds_write_b128 v13, v[96:99] offset:16384
    s_waitcnt lgkmcnt(6)
    v_mfma_f32_32x32x16_bf16 v[32:47], a[32:35], v[192:195], v[32:47]
    buffer_load_dwordx4 a[252:255], v31, s[44:47], s97 offen offset:3072 sc1
    v_fma_f32 v244, v244, v148, 0.5
    v_rcp_f32 v243, v243
    v_sub_f32 v242, 1.0, v242
    v_cvt_pk_bf16_f32 v100, v240, v241
    s_waitcnt lgkmcnt(5)
    v_mfma_f32_32x32x16_bf16 v[48:63], a[32:35], v[196:199], v[48:63]
    s_add_u32 s97, s23, 0
    buffer_load_dwordx4 a[0:3], v31, s[44:47], s97 offen offset:0 sc1
    v_fma_f32 v245, v245, v149, 0.5
    v_rcp_f32 v244, v244
    v_sub_f32 v243, 1.0, v243
    v_mfma_f32_32x32x16_bf16 v[80:95], a[36:39], v[196:199], v[80:95]
    ds_read_b128 v[208:211], v28 offset:12288
    v_fma_f32 v246, v246, v150, 0.5
    v_rcp_f32 v245, v245
    v_sub_f32 v244, 1.0, v244
    v_cvt_pk_bf16_f32 v101, v242, v243
    v_mfma_f32_32x32x16_bf16 v[64:79], a[36:39], v[192:195], v[64:79]
    ds_read_b128 v[212:215], v28 offset:12800
    v_fma_f32 v247, v247, v151, 0.5
    v_rcp_f32 v246, v246
    v_sub_f32 v245, 1.0, v245
    s_waitcnt lgkmcnt(6)
    v_mfma_f32_32x32x16_bf16 v[32:47], a[40:43], v[200:203], v[32:47]
    ds_read_b128 v[216:219], v28 offset:14336
    s_waitcnt lgkmcnt(4)
    v_fma_f32 v224, v224, v152, 0.5
    v_rcp_f32 v247, v247
    v_sub_f32 v246, 1.0, v246
    v_cvt_pk_bf16_f32 v102, v244, v245
    v_mfma_f32_32x32x16_bf16 v[48:63], a[40:43], v[204:207], v[48:63]
    ds_read_b128 v[220:223], v28 offset:14848
    ds_read_b128 v[232:235], v12 offset:2832
    v_fma_f32 v225, v225, v153, 0.5
    v_rcp_f32 v224, v224
    v_sub_f32 v247, 1.0, v247
    v_mfma_f32_32x32x16_bf16 v[80:95], a[44:47], v[204:207], v[80:95]
    buffer_load_dwordx4 a[4:7], v31, s[44:47], s97 offen offset:1024 sc1
    ds_read_b128 v[236:239], v12 offset:2848
    v_fma_f32 v226, v226, v154, 0.5
    v_rcp_f32 v225, v225
    v_sub_f32 v224, 1.0, v224
    v_cvt_pk_bf16_f32 v103, v246, v247
    v_mfma_f32_32x32x16_bf16 v[64:79], a[44:47], v[200:203], v[64:79]
    s_add_u32 s97, s28, 0
    buffer_load_dwordx4 a[8:11], v31, s[44:47], s97 offen offset:0 sc1
    v_fma_f32 v227, v227, v155, 0.5
    v_rcp_f32 v226, v226
    v_sub_f32 v225, 1.0, v225
    ds_write_b128 v13, v[100:103] offset:16512
    s_waitcnt lgkmcnt(6)
    v_mfma_f32_32x32x16_bf16 v[32:47], a[48:51], v[208:211], v[32:47]
    buffer_load_dwordx4 a[12:15], v31, s[44:47], s97 offen offset:1024 sc1
    v_fma_f32 v228, v228, v156, 0.5
    v_rcp_f32 v227, v227
    v_sub_f32 v226, 1.0, v226
    v_cvt_pk_bf16_f32 v96, v224, v225
    s_waitcnt lgkmcnt(5)
    v_mfma_f32_32x32x16_bf16 v[48:63], a[48:51], v[212:215], v[48:63]
    s_add_u32 s97, s23, 2048
    buffer_load_dwordx4 a[16:19], v31, s[44:47], s97 offen offset:0 sc1
    v_fma_f32 v229, v229, v157, 0.5
    v_rcp_f32 v228, v228
    v_sub_f32 v227, 1.0, v227
    v_mfma_f32_32x32x16_bf16 v[80:95], a[52:55], v[212:215], v[80:95]
    s_waitcnt lgkmcnt(0)
    s_barrier
    ds_read_b128 v[192:195], v28 offset:16384
    v_fma_f32 v230, v230, v158, 0.5
    v_rcp_f32 v229, v229
    v_sub_f32 v228, 1.0, v228
    v_cvt_pk_bf16_f32 v97, v226, v227
    v_mfma_f32_32x32x16_bf16 v[64:79], a[52:55], v[208:211], v[64:79]
    ds_read_b128 v[196:199], v28 offset:16896
    v_fma_f32 v231, v231, v159, 0.5
    v_rcp_f32 v230, v230
    v_sub_f32 v229, 1.0, v229
    v_mfma_f32_32x32x16_bf16 v[32:47], a[56:59], v[216:219], v[32:47]
    ds_read_b128 v[200:203], v28 offset:18432
    v_fma_f32 v232, v232, v152, 0.5
    v_rcp_f32 v231, v231
    v_sub_f32 v230, 1.0, v230
    v_cvt_pk_bf16_f32 v98, v228, v229
    v_mfma_f32_32x32x16_bf16 v[48:63], a[56:59], v[220:223], v[48:63]
    ds_read_b128 v[204:207], v28 offset:18944
    ds_read_b128 v[240:243], v12 offset:1024
    v_fma_f32 v233, v233, v153, 0.5
    v_rcp_f32 v232, v232
    v_sub_f32 v231, 1.0, v231
    v_mfma_f32_32x32x16_bf16 v[80:95], a[60:63], v[220:223], v[80:95]
    buffer_load_dwordx4 a[20:23], v31, s[44:47], s97 offen offset:1024 sc1
    ds_read_b128 v[244:247], v12 offset:1040
    v_fma_f32 v234, v234, v154, 0.5
    v_rcp_f32 v233, v233
    v_sub_f32 v232, 1.0, v232
    v_cvt_pk_bf16_f32 v99, v230, v231
    v_mfma_f32_32x32x16_bf16 v[64:79], a[60:63], v[216:219], v[64:79]
    s_add_u32 s97, s28, 2048
    buffer_load_dwordx4 a[24:27], v31, s[44:47], s97 offen offset:0 sc1
    v_fma_f32 v235, v235, v155, 0.5
    v_rcp_f32 v234, v234
    v_sub_f32 v233, 1.0, v233
    s_nop 0
L_PAD5:
    s_cbranch_execz L_PADRET
    ds_write_b128 v13, v[96:99] offset:24576
    s_waitcnt lgkmcnt(6)
    v_mfma_f32_32x32x16_bf16 v[32:47], a[64:67], v[192:195], v[32:47]
    buffer_load_dwordx4 a[28:31], v31, s[44:47], s97 offen offset:1024 sc1
    v_fma_f32 v236, v236, v156, 0.5
    v_rcp_f32 v235, v235
    v_sub_f32 v234, 1.0, v234
    v_cvt_pk_bf16_f32 v100, v232, v233
    s_waitcnt lgkmcnt(5)
    v_mfma_f32_32x32x16_bf16 v[48:63], a[64:67], v[196:199], v[48:63]
    s_add_u32 s97, s23, 4096
    buffer_load_dwordx4 a[32:35], v31, s[44:47], s97 offen offset:0 sc1
    v_fma_f32 v237, v237, v157, 0.5
    v_rcp_f32 v236, v236
    v_sub_f32 v235, 1.0, v235
    v_mfma_f32_32x32x16_bf16 v[80:95], a[68:71], v[196:199], v[80:95]
    ds_read_b128 v[208:211], v28 offset:20480
    v_fma_f32 v238, v238, v158, 0.5
    v_rcp_f32 v237, v237
    v_sub_f32 v236, 1.0, v236
    v_cvt_pk_bf16_f32 v101, v234, v235
    v_mfma_f32_32x32x16_bf16 v[64:79], a[68:71], v[192:195], v[64:79]
    ds_read_b128 v[212:215], v28 offset:20992
    v_fma_f32 v239, v239, v159, 0.5
    v_rcp_f32 v238, v238
    v_sub_f32 v237, 1.0, v237
    s_waitcnt lgkmcnt(6)
    v_mfma_f32_32x32x16_bf16 v[32:47], a[72:75], v[200:203], v[32:47]
    ds_read_b128 v[216:219], v28 offset:22528
    s_waitcnt lgkmcnt(4)
    v_fma_f32 v240, v240, v160, 0.5
    v_rcp_f32 v239, v239
    v_sub_f32 v238, 1.0, v238
    v_cvt_pk_bf16_f32 v102, v236, v237
    v_mfma_f32_32x32x16_bf16 v[48:63], a[72:75], v[204:207], v[48:63]
    ds_read_b128 v[220:223], v28 offset:23040
    ds_read_b128 v[224:227], v12 offset:3088
    v_fma_f32 v241, v241, v161, 0.5
    v_rcp_f32 v240, v240
    v_sub_f32 v239, 1.0, v239
    v_mfma_f32_32x32x16_bf16 v[80:95], a[76:79], v[204:207], v[80:95]
    buffer_load_dwordx4 a[36:39], v31, s[44:47], s97 offen offset:1024 sc1
    ds_read_b128 v[228:231], v12 offset:3104
    v_fma_f32 v242, v242, v162, 0.5
    v_rcp_f32 v241, v241
    v_sub_f32 v240, 1.0, v240
    v_cvt_pk_bf16_f32 v103, v238, v239
    v_mfma_f32_32x32x16_bf16 v[64:79], a[76:79], v[200:203], v[64:79]
    s_add_u32 s97, s28, 4096
    buffer_load_dwordx4 a[40:43], v31, s[44:47], s97 offen offset:0 sc1
    v_fma_f32 v243, v243, v163, 0.5
    v_rcp_f32 v242, v242
    v_sub_f32 v241, 1.0, v241
    ds_write_b128 v13, v[100:103] offset:24704
    s_waitcnt lgkmcnt(6)
    v_mfma_f32_32x32x16_bf16 v[32:47], a[80:83], v[208:211], v[32:47]
    buffer_load_dwordx4 a[44:47], v31, s[44:47], s97 offen offset:1024 sc1
    v_fma_f32 v244, v244, v164, 0.5
    v_rcp_f32 v243, v243
    v_sub_f32 v242, 1.0, v242
    v_cvt_pk_bf16_f32 v96, v240, v241
    s_waitcnt lgkmcnt(5)
    v_mfma_f32_32x32x16_bf16 v[48:63], a[80:83], v[212:215], v[48:63]
    s_add_u32 s97, s23, 6144
    buffer_load_dwordx4 a[48:51], v31, s[44:47], s97 offen offset:0 sc1
    v_fma_f32 v245, v245, v165, 0.5
    v_rcp_f32 v244, v244
    v_sub_f32 v243, 1.0, v243
    v_mfma_f32_32x32x16_bf16 v[80:95], a[84:87], v[212:215], v[80:95]
    s_waitcnt lgkmcnt(0)
    s_barrier
    ds_read_b128 v[192:195], v28 offset:24576
    v_fma_f32 v246, v246, v166, 0.5
    v_rcp_f32 v245, v245
    v_sub_f32 v244, 1.0, v244
    v_cvt_pk_bf16_f32 v97, v242, v243
    v_mfma_f32_32x32x16_bf16 v[64:79], a[84:87], v[208:211], v[64:79]
    ds_read_b128 v[196:199], v28 offset:25088
    v_fma_f32 v247, v247, v167, 0.5
    v_rcp_f32 v246, v246
    v_sub_f32 v245, 1.0, v245
    v_mfma_f32_32x32x16_bf16 v[32:47], a[88:91], v[216:219], v[32:47]
    ds_read_b128 v[200:203], v28 offset:26624
    v_fma_f32 v224, v224, v160, 0.5
    v_rcp_f32 v247, v247
    v_sub_f32 v246, 1.0, v246
    v_cvt_pk_bf16_f32 v98, v244, v245
    v_mfma_f32_32x32x16_bf16 v[48:63], a[88:91], v[220:223], v[48:63]
    ds_read_b128 v[204:207], v28 offset:27136
    ds_read_b128 v[232:235], v12 offset:1280
    v_fma_f32 v225, v225, v161, 0.5
    v_rcp_f32 v224, v224
    v_sub_f32 v247, 1.0, v247
    v_mfma_f32_32x32x16_bf16 v[80:95], a[92:95], v[220:223], v[80:95]
    buffer_load_dwordx4 a[52:55], v31, s[44:47], s97 offen offset:1024 sc1
    ds_read_b128 v[236:239], v12 offset:1296
    v_fma_f32 v226, v226, v162, 0.5
    v_rcp_f32 v225, v225
    v_sub_f32 v224, 1.0, v224
    v_cvt_pk_bf16_f32 v99, v246, v247
    v_mfma_f32_32x32x16_bf16 v[64:79], a[92:95], v[216:219], v[64:79]
    s_add_u32 s97, s28, 6144
    buffer_load_dwordx4 a[56:59], v31, s[44:47], s97 offen offset:0 sc1
    v_fma_f32 v227, v227, v163, 0.5
    v_rcp_f32 v226, v226
    v_sub_f32 v225, 1.0, v225
    ds_write_b128 v13, v[96:99] offset:32768
    s_waitcnt lgkmcnt(6)
    v_mfma_f32_32x32x16_bf16 v[32:47], a[96:99], v[192:195], v[32:47]
    buffer_load_dwordx4 a[60:63], v31, s[44:47], s97 offen offset:1024 sc1
    v_fma_f32 v228, v228, v164, 0.5
    v_rcp_f32 v227, v227
    v_sub_f32 v226, 1.0, v226
    v_cvt_pk_bf16_f32 v100, v224, v225
    s_waitcnt lgkmcnt(5)
    v_mfma_f32_32x32x16_bf16 v[48:63], a[96:99], v[196:199], v[48:63]
    s_add_u32 s97, s23, 8192
    buffer_load_dwordx4 a[64:67], v31, s[44:47], s97 offen offset:0 sc1
    v_fma_f32 v229, v229, v165, 0.5
    v_rcp_f32 v228, v228
    v_sub_f32 v227, 1.0, v227
    v_mfma_f32_32x32x16_bf16 v[80:95], a[100:103], v[196:199], v[80:95]
    ds_read_b128 v[208:211], v28 offset:28672
    v_fma_f32 v230, v230, v166, 0.5
    v_rcp_f32 v229, v229
    v_sub_f32 v228, 1.0, v228
    v_cvt_pk_bf16_f32 v101, v226, v227
    v_mfma_f32_32x32x16_bf16 v[64:79], a[100:103], v[192:195], v[64:79]
    ds_read_b128 v[212:215], v28 offset:29184
    v_fma_f32 v231, v231, v167, 0.5
    v_rcp_f32 v230, v230
    v_sub_f32 v229, 1.0, v229
    s_waitcnt lgkmcnt(6)
    v_mfma_f32_32x32x16_bf16 v[32:47], a[104:107], v[200:203], v[32:47]
    ds_read_b128 v[216:219], v28 offset:30720
    s_waitcnt lgkmcnt(4)
    v_fma_f32 v232, v232, v168, 0.5
    v_rcp_f32 v231, v231
    v_sub_f32 v230, 1.0, v230
    v_cvt_pk_bf16_f32 v102, v228, v229
    v_mfma_f32_32x32x16_bf16 v[48:63], a[104:107], v[204:207], v[48:63]
    ds_read_b128 v[220:223], v28 offset:31232
    ds_read_b128 v[240:243], v12 offset:3344
    v_fma_f32 v233, v233, v169, 0.5
    v_rcp_f32 v232, v232
    v_sub_f32 v231, 1.0, v231
    v_mfma_f32_32x32x16_bf16 v[80:95], a[108:111], v[204:207], v[80:95]
    buffer_load_dwordx4 a[68:71], v31, s[44:47], s97 offen offset:1024 sc1
    ds_read_b128 v[244:247], v12 offset:3360
    v_fma_f32 v234, v234, v170, 0.5
    v_rcp_f32 v233, v233
    v_sub_f32 v232, 1.0, v232
    v_cvt_pk_bf16_f32 v103, v230, v231
    v_mfma_f32_32x32x16_bf16 v[64:79], a[108:111], v[200:203], v[64:79]
    s_add_u32 s97, s28, 8192
    buffer_load_dwordx4 a[72:75], v31, s[44:47], s97 offen offset:0 sc1
    v_fma_f32 v235, v235, v171, 0.5
    v_rcp_f32 v234, v234
    v_sub_f32 v233, 1.0, v233
    ds_write_b128 v13, v[100:103] offset:32896
    s_waitcnt vmcnt(51) lgkmcnt(6)
    v_mfma_f32_32x32x16_bf16 v[32:47], a[112:115], v[208:211], v[32:47]
    buffer_load_dwordx4 a[76:79], v31, s[44:47], s97 offen offset:1024 sc1
    v_fma_f32 v236, v236, v172, 0.5
    v_rcp_f32 v235, v235
    v_sub_f32 v234, 1.0, v234
    v_cvt_pk_bf16_f32 v96, v232, v233
    s_waitcnt lgkmcnt(5)
    v_mfma_f32_32x32x16_bf16 v[48:63], a[112:115], v[212:215], v[48:63]
    s_add_u32 s97, s23, 10240
    buffer_load_dwordx4 a[80:83], v31, s[44:47], s97 offen offset:0 sc1
    v_fma_f32 v237, v237, v173, 0.5
    v_rcp_f32 v236, v236
    v_sub_f32 v235, 1.0, v235
    v_mfma_f32_32x32x16_bf16 v[80:95], a[116:119], v[212:215], v[80:95]
    s_waitcnt lgkmcnt(0)
    s_barrier
    ds_read_b128 v[192:195], v28 offset:32768
    v_fma_f32 v238, v238, v174, 0.5
    v_rcp_f32 v237, v237
    v_sub_f32 v236, 1.0, v236
    v_cvt_pk_bf16_f32 v97, v234, v235
    v_mfma_f32_32x32x16_bf16 v[64:79], a[116:119], v[208:211], v[64:79]
    ds_read_b128 v[196:199], v28 offset:33280
    v_fma_f32 v239, v239, v175, 0.5
    v_rcp_f32 v238, v238
    v_sub_f32 v237, 1.0, v237
    v_mfma_f32_32x32x16_bf16 v[32:47], a[120:123], v[216:219], v[32:47]
    ds_read_b128 v[200:203], v28 offset:34816
    v_fma_f32 v240, v240, v168, 0.5
    v_rcp_f32 v239, v239
    v_sub_f32 v238, 1.0, v238
    v_cvt_pk_bf16_f32 v98, v236, v237
    v_mfma_f32_32x32x16_bf16 v[48:63], a[120:123], v[220:223], v[48:63]
    ds_read_b128 v[204:207], v28 offset:35328
    ds_read_b128 v[224:227], v12 offset:1536
    v_fma_f32 v241, v241, v169, 0.5
    v_rcp_f32 v240, v240
    v_sub_f32 v239, 1.0, v239
    v_mfma_f32_32x32x16_bf16 v[80:95], a[124:127], v[220:223], v[80:95]
    buffer_load_dwordx4 a[84:87], v31, s[44:47], s97 offen offset:1024 sc1
    ds_read_b128 v[228:231], v12 offset:1552
    v_fma_f32 v242, v242, v170, 0.5
    v_rcp_f32 v241, v241
    v_sub_f32 v240, 1.0, v240
    v_cvt_pk_bf16_f32 v99, v238, v239
    v_mfma_f32_32x32x16_bf16 v[64:79], a[124:127], v[216:219], v[64:79]
    s_add_u32 s97, s28, 10240
    buffer_load_dwordx4 a[88:91], v31, s[44:47], s97 offen offset:0 sc1
    v_fma_f32 v243, v243, v171, 0.5
    v_rcp_f32 v242, v242
    v_sub_f32 v241, 1.0, v241
    ds_write_b128 v13, v[96:99] offset:40960
    s_waitcnt vmcnt(51) lgkmcnt(6)
    v_mfma_f32_32x32x16_bf16 v[32:47], a[128:131], v[192:195], v[32:47]
    buffer_load_dwordx4 a[92:95], v31, s[44:47], s97 offen offset:1024 sc1
    v_fma_f32 v244, v244, v172, 0.5
    v_rcp_f32 v243, v243
    v_sub_f32 v242, 1.0, v242
    v_cvt_pk_bf16_f32 v100, v240, v241
    s_waitcnt lgkmcnt(5)
    v_mfma_f32_32x32x16_bf16 v[48:63], a[128:131], v[196:199], v[48:63]
    s_add_u32 s97, s23, 12288
    buffer_load_dwordx4 a[96:99], v31, s[44:47], s97 offen offset:0 sc1
    v_fma_f32 v245, v245, v173, 0.5
    v_rcp_f32 v244, v244
    v_sub_f32 v243, 1.0, v243
    v_mfma_f32_32x32x16_bf16 v[80:95], a[132:135], v[196:199], v[80:95]
    ds_read_b128 v[208:211], v28 offset:36864
    v_fma_f32 v246, v246, v174, 0.5
    v_rcp_f32 v245, v245
    v_sub_f32 v244, 1.0, v244
    v_cvt_pk_bf16_f32 v101, v242, v243
    v_mfma_f32_32x32x16_bf16 v[64:79], a[132:135], v[192:195], v[64:79]
    ds_read_b128 v[212:215], v28 offset:37376
    v_fma_f32 v247, v247, v175, 0.5
    v_rcp_f32 v246, v246
    v_sub_f32 v245, 1.0, v245
    s_waitcnt lgkmcnt(6)
    v_mfma_f32_32x32x16_bf16 v[32:47], a[136:139], v[200:203], v[32:47]
    ds_read_b128 v[216:219], v28 offset:38912
    s_waitcnt lgkmcnt(4)
    v_fma_f32 v224, v224, v176, 0.5
    v_rcp_f32 v247, v247
    v_sub_f32 v246, 1.0, v246
    v_cvt_pk_bf16_f32 v102, v244, v245
    v_mfma_f32_32x32x16_bf16 v[48:63], a[136:139], v[204:207], v[48:63]
    ds_read_b128 v[220:223], v28 offset:39424
    ds_read_b128 v[232:235], v12 offset:3600
    v_fma_f32 v225, v225, v177, 0.5
    v_rcp_f32 v224, v224
    v_sub_f32 v247, 1.0, v247
    v_mfma_f32_32x32x16_bf16 v[80:95], a[140:143], v[204:207], v[80:95]
    buffer_load_dwordx4 a[100:103], v31, s[44:47], s97 offen offset:1024 sc1
    ds_read_b128 v[236:239], v12 offset:3616
    v_fma_f32 v226, v226, v178, 0.5
    v_rcp_f32 v225, v225
    v_sub_f32 v224, 1.0, v224
    v_cvt_pk_bf16_f32 v103, v246, v247
    v_mfma_f32_32x32x16_bf16 v[64:79], a[140:143], v[200:203], v[64:79]
    s_add_u32 s97, s28, 12288
    buffer_load_dwordx4 a[104:107], v31, s[44:47], s97 offen offset:0 sc1
    v_fma_f32 v227, v227, v179, 0.5
    v_rcp_f32 v226, v226
    v_sub_f32 v225, 1.0, v225
    ds_write_b128 v13, v[100:103] offset:41088
    s_waitcnt vmcnt(51) lgkmcnt(6)
    v_mfma_f32_32x32x16_bf16 v[32:47], a[144:147], v[208:211], v[32:47]
    buffer_load_dwordx4 a[108:111], v31, s[44:47], s97 offen offset:1024 sc1
    v_fma_f32 v228, v228, v180, 0.5
    v_rcp_f32 v227, v227
    v_sub_f32 v226, 1.0, v226
    v_cvt_pk_bf16_f32 v96, v224, v225
    s_waitcnt lgkmcnt(5)
    v_mfma_f32_32x32x16_bf16 v[48:63], a[144:147], v[212:215], v[48:63]
    s_add_u32 s97, s23, 14336
    buffer_load_dwordx4 a[112:115], v31, s[44:47], s97 offen offset:0 sc1
    v_fma_f32 v229, v229, v181, 0.5
    v_rcp_f32 v228, v228
    v_sub_f32 v227, 1.0, v227
    v_mfma_f32_32x32x16_bf16 v[80:95], a[148:151], v[212:215], v[80:95]
    s_waitcnt lgkmcnt(0)
    s_barrier
    ds_read_b128 v[192:195], v28 offset:40960
    v_fma_f32 v230, v230, v182, 0.5
    v_rcp_f32 v229, v229
    v_sub_f32 v228, 1.0, v228
    v_cvt_pk_bf16_f32 v97, v226, v227
    v_mfma_f32_32x32x16_bf16 v[64:79], a[148:151], v[208:211], v[64:79]
    ds_read_b128 v[196:199], v28 offset:41472
    v_fma_f32 v231, v231, v183, 0.5
    v_rcp_f32 v230, v230
    v_sub_f32 v229, 1.0, v229
    v_mfma_f32_32x32x16_bf16 v[32:47], a[152:155], v[216:219], v[32:47]
    ds_read_b128 v[200:203], v28 offset:43008
    v_fma_f32 v232, v232, v176, 0.5
    v_rcp_f32 v231, v231
    v_sub_f32 v230, 1.0, v230
    v_cvt_pk_bf16_f32 v98, v228, v229
    v_mfma_f32_32x32x16_bf16 v[48:63], a[152:155], v[220:223], v[48:63]
    ds_read_b128 v[204:207], v28 offset:43520
    ds_read_b128 v[240:243], v12 offset:1792
    v_fma_f32 v233, v233, v177, 0.5
    v_rcp_f32 v232, v232
    v_sub_f32 v231, 1.0, v231
    v_mfma_f32_32x32x16_bf16 v[80:95], a[156:159], v[220:223], v[80:95]
    buffer_load_dwordx4 a[116:119], v31, s[44:47], s97 offen offset:1024 sc1
    ds_read_b128 v[244:247], v12 offset:1808
    v_fma_f32 v234, v234, v178, 0.5
    v_rcp_f32 v233, v233
    v_sub_f32 v232, 1.0, v232
    v_cvt_pk_bf16_f32 v99, v230, v231
    v_mfma_f32_32x32x16_bf16 v[64:79], a[156:159], v[216:219], v[64:79]
    s_add_u32 s97, s28, 14336
    buffer_load_dwordx4 a[120:123], v31, s[44:47], s97 offen offset:0 sc1
    v_fma_f32 v235, v235, v179, 0.5
    v_rcp_f32 v234, v234
    v_sub_f32 v233, 1.0, v233
    ds_write_b128 v13, v[96:99] offset:49152
    s_waitcnt vmcnt(51) lgkmcnt(6)
    v_mfma_f32_32x32x16_bf16 v[32:47], a[160:163], v[192:195], v[32:47]
    buffer_load_dwordx4 a[124:127], v31, s[44:47], s97 offen offset:1024 sc1
    v_fma_f32 v236, v236, v180, 0.5
    v_rcp_f32 v235, v235
    v_sub_f32 v234, 1.0, v234
    v_cvt_pk_bf16_f32 v100, v232, v233
    s_waitcnt lgkmcnt(5)
    v_mfma_f32_32x32x16_bf16 v[48:63], a[160:163], v[196:199], v[48:63]
    s_add_u32 s97, s23, 16384
    buffer_load_dwordx4 a[128:131], v31, s[44:47], s97 offen offset:0 sc1
    v_fma_f32 v237, v237, v181, 0.5
    v_rcp_f32 v236, v236
    v_sub_f32 v235, 1.0, v235
    v_mfma_f32_32x32x16_bf16 v[80:95], a[164:167], v[196:199], v[80:95]
    ds_read_b128 v[208:211], v28 offset:45056
    v_fma_f32 v238, v238, v182, 0.5
    v_rcp_f32 v237, v237
    v_sub_f32 v236, 1.0, v236
    v_cvt_pk_bf16_f32 v101, v234, v235
    v_mfma_f32_32x32x16_bf16 v[64:79], a[164:167], v[192:195], v[64:79]
    ds_read_b128 v[212:215], v28 offset:45568
    v_fma_f32 v239, v239, v183, 0.5
    v_rcp_f32 v238, v238
    v_sub_f32 v237, 1.0, v237
    s_waitcnt lgkmcnt(6)
    v_mfma_f32_32x32x16_bf16 v[32:47], a[168:171], v[200:203], v[32:47]
    ds_read_b128 v[216:219], v28 offset:47104
    s_waitcnt lgkmcnt(4)
    v_fma_f32 v240, v240, v184, 0.5
    v_rcp_f32 v239, v239
    v_sub_f32 v238, 1.0, v238
    v_cvt_pk_bf16_f32 v102, v236, v237
    v_mfma_f32_32x32x16_bf16 v[48:63], a[168:171], v[204:207], v[48:63]
    ds_read_b128 v[220:223], v28 offset:47616
    ds_read_b128 v[224:227], v12 offset:3856
    v_fma_f32 v241, v241, v185, 0.5
    v_rcp_f32 v240, v240
    v_sub_f32 v239, 1.0, v239
    v_mfma_f32_32x32x16_bf16 v[80:95], a[172:175], v[204:207], v[80:95]
    buffer_load_dwordx4 a[132:135], v31, s[44:47], s97 offen offset:1024 sc1
    ds_read_b128 v[228:231], v12 offset:3872
    v_fma_f32 v242, v242, v186, 0.5
    v_rcp_f32 v241, v241
    v_sub_f32 v240, 1.0, v240
    v_cvt_pk_bf16_f32 v103, v238, v239
    v_mfma_f32_32x32x16_bf16 v[64:79], a[172:175], v[200:203], v[64:79]
    s_add_u32 s97, s28, 16384
    buffer_load_dwordx4 a[136:139], v31, s[44:47], s97 offen offset:0 sc1
    v_fma_f32 v243, v243, v187, 0.5
    v_rcp_f32 v242, v242
    v_sub_f32 v241, 1.0, v241
    ds_write_b128 v13, v[100:103] offset:49280
    s_waitcnt vmcnt(51) lgkmcnt(6)
    v_mfma_f32_32x32x16_bf16 v[32:47], a[176:179], v[208:211], v[32:47]
    buffer_load_dwordx4 a[140:143], v31, s[44:47], s97 offen offset:1024 sc1
    v_fma_f32 v244, v244, v188, 0.5
    v_rcp_f32 v243, v243
    v_sub_f32 v242, 1.0, v242
    v_cvt_pk_bf16_f32 v96, v240, v241
    s_waitcnt lgkmcnt(5)
    v_mfma_f32_32x32x16_bf16 v[48:63], a[176:179], v[212:215], v[48:63]
    s_add_u32 s97, s23, 18432
    buffer_load_dwordx4 a[144:147], v31, s[44:47], s97 offen offset:0 sc1
    v_fma_f32 v245, v245, v189, 0.5
    v_rcp_f32 v244, v244
    v_sub_f32 v243, 1.0, v243
    v_mfma_f32_32x32x16_bf16 v[80:95], a[180:183], v[212:215], v[80:95]
    s_waitcnt lgkmcnt(0)
    s_barrier
    ds_read_b128 v[192:195], v28 offset:49152
    v_fma_f32 v246, v246, v190, 0.5
    v_rcp_f32 v245, v245
    v_sub_f32 v244, 1.0, v244
    v_cvt_pk_bf16_f32 v97, v242, v243
    v_mfma_f32_32x32x16_bf16 v[64:79], a[180:183], v[208:211], v[64:79]
    ds_read_b128 v[196:199], v28 offset:49664
    v_fma_f32 v247, v247, v191, 0.5
    v_rcp_f32 v246, v246
    v_sub_f32 v245, 1.0, v245
    v_mfma_f32_32x32x16_bf16 v[32:47], a[184:187], v[216:219], v[32:47]
    ds_read_b128 v[200:203], v28 offset:51200
    v_fma_f32 v224, v224, v184, 0.5
    v_rcp_f32 v247, v247
    v_sub_f32 v246, 1.0, v246
    v_cvt_pk_bf16_f32 v98, v244, v245
    v_mfma_f32_32x32x16_bf16 v[48:63], a[184:187], v[220:223], v[48:63]
    ds_read_b128 v[204:207], v28 offset:51712
    v_fma_f32 v225, v225, v185, 0.5
    v_rcp_f32 v224, v224
    v_sub_f32 v247, 1.0, v247
    v_mfma_f32_32x32x16_bf16 v[80:95], a[188:191], v[220:223], v[80:95]
    buffer_load_dwordx4 a[148:151], v31, s[44:47], s97 offen offset:1024 sc1
    v_fma_f32 v226, v226, v186, 0.5
    v_rcp_f32 v225, v225
    v_sub_f32 v224, 1.0, v224
    v_cvt_pk_bf16_f32 v99, v246, v247
    v_mfma_f32_32x32x16_bf16 v[64:79], a[188:191], v[216:219], v[64:79]
    s_add_u32 s97, s28, 18432
    buffer_load_dwordx4 a[152:155], v31, s[44:47], s97 offen offset:0 sc1
    v_fma_f32 v227, v227, v187, 0.5
    v_rcp_f32 v226, v226
    v_sub_f32 v225, 1.0, v225
    ds_write_b128 v13, v[96:99] offset:57344
    s_waitcnt vmcnt(51) lgkmcnt(4)
    v_mfma_f32_32x32x16_bf16 v[32:47], a[192:195], v[192:195], v[32:47]
    buffer_load_dwordx4 a[156:159], v31, s[44:47], s97 offen offset:1024 sc1
    v_fma_f32 v228, v228, v188, 0.5
    v_rcp_f32 v227, v227
    v_sub_f32 v226, 1.0, v226
    v_cvt_pk_bf16_f32 v100, v224, v225
    s_waitcnt lgkmcnt(3)
    v_mfma_f32_32x32x16_bf16 v[48:63], a[192:195], v[196:199], v[48:63]
    s_add_u32 s97, s23, 20480
    buffer_load_dwordx4 a[160:163], v31, s[44:47], s97 offen offset:0 sc1
    v_fma_f32 v229, v229, v189, 0.5
    v_rcp_f32 v228, v228
    v_sub_f32 v227, 1.0, v227
    v_mfma_f32_32x32x16_bf16 v[80:95], a[196:199], v[196:199], v[80:95]
    ds_read_b128 v[208:211], v28 offset:53248
    v_fma_f32 v230, v230, v190, 0.5
    v_rcp_f32 v229, v229
    v_sub_f32 v228, 1.0, v228
    v_cvt_pk_bf16_f32 v101, v226, v227
    v_mfma_f32_32x32x16_bf16 v[64:79], a[196:199], v[192:195], v[64:79]
    ds_read_b128 v[212:215], v28 offset:53760
    v_fma_f32 v231, v231, v191, 0.5
    v_rcp_f32 v230, v230
    v_sub_f32 v229, 1.0, v229
    s_waitcnt lgkmcnt(4)
    v_mfma_f32_32x32x16_bf16 v[32:47], a[200:203], v[200:203], v[32:47]
    ds_read_b128 v[216:219], v28 offset:55296
    v_rcp_f32 v231, v231
    v_sub_f32 v230, 1.0, v230
    v_cvt_pk_bf16_f32 v102, v228, v229
    s_waitcnt lgkmcnt(4)
    v_mfma_f32_32x32x16_bf16 v[48:63], a[200:203], v[204:207], v[48:63]
    ds_read_b128 v[220:223], v28 offset:55808
    v_sub_f32 v231, 1.0, v231
    v_mfma_f32_32x32x16_bf16 v[80:95], a[204:207], v[204:207], v[80:95]
    buffer_load_dwordx4 a[164:167], v31, s[44:47], s97 offen offset:1024 sc1
    v_cvt_pk_bf16_f32 v103, v230, v231
    v_mfma_f32_32x32x16_bf16 v[64:79], a[204:207], v[200:203], v[64:79]
    s_add_u32 s97, s28, 20480
    buffer_load_dwordx4 a[168:171], v31, s[44:47], s97 offen offset:0 sc1
    ds_write_b128 v13, v[100:103] offset:57472
    s_waitcnt vmcnt(51) lgkmcnt(4)
    v_mfma_f32_32x32x16_bf16 v[32:47], a[208:211], v[208:211], v[32:47]
    buffer_load_dwordx4 a[172:175], v31, s[44:47], s97 offen offset:1024 sc1
    s_waitcnt lgkmcnt(3)
    v_mfma_f32_32x32x16_bf16 v[48:63], a[208:211], v[212:215], v[48:63]
    s_add_u32 s97, s23, 22528
    buffer_load_dwordx4 a[176:179], v31, s[44:47], s97 offen offset:0 sc1
    v_mfma_f32_32x32x16_bf16 v[80:95], a[212:215], v[212:215], v[80:95]
    s_waitcnt lgkmcnt(0)
    s_barrier
    ds_read_b128 v[192:195], v28 offset:57344
    v_mfma_f32_32x32x16_bf16 v[64:79], a[212:215], v[208:211], v[64:79]
    ds_read_b128 v[196:199], v28 offset:57856
    v_mfma_f32_32x32x16_bf16 v[32:47], a[216:219], v[216:219], v[32:47]
    ds_read_b128 v[200:203], v28 offset:59392
    v_mfma_f32_32x32x16_bf16 v[48:63], a[216:219], v[220:223], v[48:63]
    ds_read_b128 v[204:207], v28 offset:59904
    v_mfma_f32_32x32x16_bf16 v[80:95], a[220:223], v[220:223], v[80:95]
    buffer_load_dwordx4 a[180:183], v31, s[44:47], s97 offen offset:1024 sc1
    v_mfma_f32_32x32x16_bf16 v[64:79], a[220:223], v[216:219], v[64:79]
    s_add_u32 s97, s28, 22528
    buffer_load_dwordx4 a[184:187], v31, s[44:47], s97 offen offset:0 sc1
    s_waitcnt vmcnt(51) lgkmcnt(3)
    v_mfma_f32_32x32x16_bf16 v[32:47], a[224:227], v[192:195], v[32:47]
    buffer_load_dwordx4 a[188:191], v31, s[44:47], s97 offen offset:1024 sc1
    s_waitcnt lgkmcnt(2)
    v_mfma_f32_32x32x16_bf16 v[48:63], a[224:227], v[196:199], v[48:63]
    s_add_u32 s97, s23, 24576
    buffer_load_dwordx4 a[192:195], v31, s[44:47], s97 offen offset:0 sc1
    v_mfma_f32_32x32x16_bf16 v[80:95], a[228:231], v[196:199], v[80:95]
    ds_read_b128 v[208:211], v28 offset:61440
    v_mfma_f32_32x32x16_bf16 v[64:79], a[228:231], v[192:195], v[64:79]
    ds_read_b128 v[212:215], v28 offset:61952
    s_waitcnt lgkmcnt(3)
    v_mfma_f32_32x32x16_bf16 v[32:47], a[232:235], v[200:203], v[32:47]
    ds_read_b128 v[216:219], v28 offset:63488
    s_waitcnt lgkmcnt(3)
    v_mfma_f32_32x32x16_bf16 v[48:63], a[232:235], v[204:207], v[48:63]
    ds_read_b128 v[220:223], v28 offset:64000
    v_mfma_f32_32x32x16_bf16 v[80:95], a[236:239], v[204:207], v[80:95]
    buffer_load_dwordx4 a[196:199], v31, s[44:47], s97 offen offset:1024 sc1
    v_mfma_f32_32x32x16_bf16 v[64:79], a[236:239], v[200:203], v[64:79]
    s_add_u32 s97, s28, 24576
    buffer_load_dwordx4 a[200:203], v31, s[44:47], s97 offen offset:0 sc1
    s_waitcnt vmcnt(51) lgkmcnt(3)
    v_mfma_f32_32x32x16_bf16 v[32:47], a[240:243], v[208:211], v[32:47]
    buffer_load_dwordx4 a[204:207], v31, s[44:47], s97 offen offset:1024 sc1
    s_waitcnt lgkmcnt(2)
    v_mfma_f32_32x32x16_bf16 v[48:63], a[240:243], v[212:215], v[48:63]
    s_add_u32 s97, s23, 26624
    buffer_load_dwordx4 a[208:211], v31, s[44:47], s97 offen offset:0 sc1
    v_mfma_f32_32x32x16_bf16 v[80:95], a[244:247], v[212:215], v[80:95]
    ds_read_b128 v[192:195], v25 offset:0
    v_mfma_f32_32x32x16_bf16 v[64:79], a[244:247], v[208:211], v[64:79]
    ds_read_b128 v[196:199], v25 offset:256
    s_waitcnt lgkmcnt(3)
    v_mfma_f32_32x32x16_bf16 v[32:47], a[248:251], v[216:219], v[32:47]
    ds_read_b128 v[200:203], v25 offset:4096
    s_waitcnt lgkmcnt(3)
    v_mfma_f32_32x32x16_bf16 v[48:63], a[248:251], v[220:223], v[48:63]
    ds_read_b128 v[204:207], v25 offset:4352
    v_mfma_f32_32x32x16_bf16 v[80:95], a[252:255], v[220:223], v[80:95]
    buffer_load_dwordx4 a[212:215], v31, s[44:47], s97 offen offset:1024 sc1
    v_mfma_f32_32x32x16_bf16 v[64:79], a[252:255], v[216:219], v[64:79]
    s_add_u32 s97, s28, 26624
    buffer_load_dwordx4 a[216:219], v31, s[44:47], s97 offen offset:0 sc1
    s_waitcnt vmcnt(54) lgkmcnt(3)
    v_mfma_f32_16x16x32_bf16 v[96:99], a[0:3], v[192:195], 0
    ds_read_b128 v[208:211], v25 offset:8192
    s_waitcnt vmcnt(53)
    v_mfma_f32_16x16x32_bf16 v[100:103], a[4:7], v[192:195], 0
    buffer_load_dwordx4 a[220:223], v31, s[44:47], s97 offen offset:1024 sc1
    s_waitcnt vmcnt(53)
    v_mfma_f32_16x16x32_bf16 v[104:107], a[8:11], v[192:195], 0
    s_add_u32 s97, s23, 28672
    buffer_load_dwordx4 a[224:227], v31, s[44:47], s97 offen offset:0 sc1
    s_waitcnt vmcnt(53)
    v_mfma_f32_16x16x32_bf16 v[108:111], a[12:15], v[192:195], 0
    s_waitcnt lgkmcnt(3)
    v_mfma_f32_16x16x32_bf16 v[124:127], a[12:15], v[196:199], 0
    ds_read_b128 v[212:215], v25 offset:8448
    v_mfma_f32_16x16x32_bf16 v[120:123], a[8:11], v[196:199], 0
    buffer_load_dwordx4 a[228:231], v31, s[44:47], s97 offen offset:1024 sc1
    v_mfma_f32_16x16x32_bf16 v[116:119], a[4:7], v[196:199], 0
    v_cvt_pk_bf16_f32 v128, v32, v33
    v_mfma_f32_16x16x32_bf16 v[112:115], a[0:3], v[196:199], 0
    s_add_u32 s97, s28, 28672
    buffer_load_dwordx4 a[232:235], v31, s[44:47], s97 offen offset:0 sc1
    s_waitcnt vmcnt(54) lgkmcnt(3)
    v_mfma_f32_16x16x32_bf16 v[96:99], a[16:19], v[200:203], v[96:99]
    ds_read_b128 v[216:219], v25 offset:12288
    s_waitcnt vmcnt(53)
    v_mfma_f32_16x16x32_bf16 v[100:103], a[20:23], v[200:203], v[100:103]
    v_cvt_pk_bf16_f32 v132, v40, v41
    s_waitcnt vmcnt(52)
    v_mfma_f32_16x16x32_bf16 v[104:107], a[24:27], v[200:203], v[104:107]
    buffer_load_dwordx4 a[236:239], v31, s[44:47], s97 offen offset:1024 sc1
    s_waitcnt vmcnt(52)
    v_mfma_f32_16x16x32_bf16 v[108:111], a[28:31], v[200:203], v[108:111]
    v_cvt_pk_bf16_f32 v129, v34, v35
    s_waitcnt lgkmcnt(3)
    v_mfma_f32_16x16x32_bf16 v[124:127], a[28:31], v[204:207], v[124:127]
    ds_read_b128 v[220:223], v25 offset:12544
    v_mfma_f32_16x16x32_bf16 v[120:123], a[24:27], v[204:207], v[120:123]
    v_cvt_pk_bf16_f32 v133, v42, v43
    v_mfma_f32_16x16x32_bf16 v[116:119], a[20:23], v[204:207], v[116:119]
    s_add_u32 s97, s23, 30720
    buffer_load_dwordx4 a[240:243], v31, s[44:47], s97 offen offset:0 sc1
    v_mfma_f32_16x16x32_bf16 v[112:115], a[16:19], v[204:207], v[112:115]
    v_cvt_pk_bf16_f32 v130, v36, v37
    s_waitcnt vmcnt(52) lgkmcnt(3)
    v_mfma_f32_16x16x32_bf16 v[96:99], a[32:35], v[208:211], v[96:99]
    ds_read_b128 v[192:195], v25 offset:16384
    buffer_load_dwordx4 a[244:247], v31, s[44:47], s97 offen offset:1024 sc1
    s_waitcnt vmcnt(52)
    v_mfma_f32_16x16x32_bf16 v[100:103], a[36:39], v[208:211], v[100:103]
    v_cvt_pk_bf16_f32 v134, v44, v45
    s_waitcnt vmcnt(51)
    v_mfma_f32_16x16x32_bf16 v[104:107], a[40:43], v[208:211], v[104:107]
    s_add_u32 s97, s28, 30720
    buffer_load_dwordx4 a[248:251], v31, s[44:47], s97 offen offset:0 sc1
    s_waitcnt vmcnt(51)
    v_mfma_f32_16x16x32_bf16 v[108:111], a[44:47], v[208:211], v[108:111]
    buffer_load_dwordx4 a[252:255], v31, s[44:47], s97 offen offset:1024 sc1
    v_cvt_pk_bf16_f32 v131, v38, v39
    s_waitcnt lgkmcnt(3)
    v_mfma_f32_16x16x32_bf16 v[124:127], a[44:47], v[212:215], v[124:127]
    ds_read_b128 v[196:199], v25 offset:16640
    v_mfma_f32_16x16x32_bf16 v[120:123], a[40:43], v[212:215], v[120:123]
    v_cvt_pk_bf16_f32 v135, v46, v47
    v_mfma_f32_16x16x32_bf16 v[116:119], a[36:39], v[212:215], v[116:119]
    v_permlane16_swap_b32 v128, v132
    v_mfma_f32_16x16x32_bf16 v[112:115], a[32:35], v[212:215], v[112:115]
    v_permlane16_swap_b32 v129, v133
    s_waitcnt vmcnt(51) lgkmcnt(3)
    v_mfma_f32_16x16x32_bf16 v[96:99], a[48:51], v[216:219], v[96:99]
    ds_read_b128 v[200:203], v25 offset:20480
    s_waitcnt vmcnt(50)
    v_mfma_f32_16x16x32_bf16 v[100:103], a[52:55], v[216:219], v[100:103]
    v_permlane16_swap_b32 v130, v134
    s_waitcnt vmcnt(49)
    v_mfma_f32_16x16x32_bf16 v[104:107], a[56:59], v[216:219], v[104:107]
    s_waitcnt vmcnt(48)
    v_mfma_f32_16x16x32_bf16 v[108:111], a[60:63], v[216:219], v[108:111]
    v_permlane16_swap_b32 v131, v135
    s_waitcnt lgkmcnt(3)
    v_mfma_f32_16x16x32_bf16 v[124:127], a[60:63], v[220:223], v[124:127]
    ds_read_b128 v[204:207], v25 offset:20736
    v_mfma_f32_16x16x32_bf16 v[120:123], a[56:59], v[220:223], v[120:123]
    buffer_store_dwordx4 v[128:131], v16, s[48:51], 0 offen offset:0 sc1
    v_mfma_f32_16x16x32_bf16 v[116:119], a[52:55], v[220:223], v[116:119]
    s_nop 0
    s_nop 0
L_PAD6:
    s_cbranch_execz L_PADRET
    v_mfma_f32_16x16x32_bf16 v[112:115], a[48:51], v[220:223], v[112:115]
    buffer_store_dwordx4 v[132:135], v16, s[48:51], s100 offen offset:0 sc1
    s_waitcnt vmcnt(49) lgkmcnt(3)
    v_mfma_f32_16x16x32_bf16 v[96:99], a[64:67], v[192:195], v[96:99]
    ds_read_b128 v[208:211], v25 offset:24576
    s_waitcnt vmcnt(48)
    v_mfma_f32_16x16x32_bf16 v[100:103], a[68:71], v[192:195], v[100:103]
    s_waitcnt vmcnt(47)
    v_mfma_f32_16x16x32_bf16 v[104:107], a[72:75], v[192:195], v[104:107]
    v_cvt_pk_bf16_f32 v136, v64, v65
    s_waitcnt vmcnt(46)
    v_mfma_f32_16x16x32_bf16 v[108:111], a[76:79], v[192:195], v[108:111]
    s_waitcnt lgkmcnt(3)
    v_mfma_f32_16x16x32_bf16 v[124:127], a[76:79], v[196:199], v[124:127]
    ds_read_b128 v[212:215], v25 offset:24832
    v_mfma_f32_16x16x32_bf16 v[120:123], a[72:75], v[196:199], v[120:123]
    v_cvt_pk_bf16_f32 v140, v72, v73
    v_mfma_f32_16x16x32_bf16 v[116:119], a[68:71], v[196:199], v[116:119]
    v_cvt_pk_bf16_f32 v137, v66, v67
    v_mfma_f32_16x16x32_bf16 v[112:115], a[64:67], v[196:199], v[112:115]
    s_waitcnt vmcnt(45) lgkmcnt(3)
    v_mfma_f32_16x16x32_bf16 v[96:99], a[80:83], v[200:203], v[96:99]
    ds_read_b128 v[216:219], v25 offset:28672
    s_waitcnt vmcnt(44)
    v_mfma_f32_16x16x32_bf16 v[100:103], a[84:87], v[200:203], v[100:103]
    v_cvt_pk_bf16_f32 v141, v74, v75
    s_waitcnt vmcnt(43)
    v_mfma_f32_16x16x32_bf16 v[104:107], a[88:91], v[200:203], v[104:107]
    v_cvt_pk_bf16_f32 v138, v68, v69
    s_waitcnt vmcnt(42)
    v_mfma_f32_16x16x32_bf16 v[108:111], a[92:95], v[200:203], v[108:111]
    s_waitcnt lgkmcnt(3)
    v_mfma_f32_16x16x32_bf16 v[124:127], a[92:95], v[204:207], v[124:127]
    ds_read_b128 v[220:223], v25 offset:28928
    v_mfma_f32_16x16x32_bf16 v[120:123], a[88:91], v[204:207], v[120:123]
    v_cvt_pk_bf16_f32 v142, v76, v77
    v_mfma_f32_16x16x32_bf16 v[116:119], a[84:87], v[204:207], v[116:119]
    v_cvt_pk_bf16_f32 v139, v70, v71
    v_mfma_f32_16x16x32_bf16 v[112:115], a[80:83], v[204:207], v[112:115]
    s_waitcnt vmcnt(41) lgkmcnt(3)
    v_mfma_f32_16x16x32_bf16 v[96:99], a[96:99], v[208:211], v[96:99]
    ds_read_b128 v[192:195], v25 offset:32768
    s_waitcnt vmcnt(40)
    v_mfma_f32_16x16x32_bf16 v[100:103], a[100:103], v[208:211], v[100:103]
    v_cvt_pk_bf16_f32 v143, v78, v79
    s_waitcnt vmcnt(39)
    v_mfma_f32_16x16x32_bf16 v[104:107], a[104:107], v[208:211], v[104:107]
    s_waitcnt vmcnt(38)
    v_mfma_f32_16x16x32_bf16 v[108:111], a[108:111], v[208:211], v[108:111]
    v_permlane16_swap_b32 v136, v140
    s_waitcnt lgkmcnt(3)
    v_mfma_f32_16x16x32_bf16 v[124:127], a[108:111], v[212:215], v[124:127]
    ds_read_b128 v[196:199], v25 offset:33024
    v_mfma_f32_16x16x32_bf16 v[120:123], a[104:107], v[212:215], v[120:123]
    v_permlane16_swap_b32 v137, v141
    v_mfma_f32_16x16x32_bf16 v[116:119], a[100:103], v[212:215], v[116:119]
    v_mfma_f32_16x16x32_bf16 v[112:115], a[96:99], v[212:215], v[112:115]
    v_permlane16_swap_b32 v138, v142
    s_waitcnt vmcnt(37) lgkmcnt(3)
    v_mfma_f32_16x16x32_bf16 v[96:99], a[112:115], v[216:219], v[96:99]
    ds_read_b128 v[200:203], v25 offset:36864
    s_waitcnt vmcnt(36)
    v_mfma_f32_16x16x32_bf16 v[100:103], a[116:119], v[216:219], v[100:103]
    v_permlane16_swap_b32 v139, v143
    s_waitcnt vmcnt(35)
    v_mfma_f32_16x16x32_bf16 v[104:107], a[120:123], v[216:219], v[104:107]
    s_waitcnt vmcnt(34)
    v_mfma_f32_16x16x32_bf16 v[108:111], a[124:127], v[216:219], v[108:111]
    buffer_store_dwordx4 v[136:139], v16, s[48:51], 0 offen offset:64 sc1
    s_waitcnt lgkmcnt(3)
    v_mfma_f32_16x16x32_bf16 v[124:127], a[124:127], v[220:223], v[124:127]
    ds_read_b128 v[204:207], v25 offset:37120
    v_mfma_f32_16x16x32_bf16 v[120:123], a[120:123], v[220:223], v[120:123]
    buffer_store_dwordx4 v[140:143], v16, s[48:51], s100 offen offset:64 sc1
    v_mfma_f32_16x16x32_bf16 v[116:119], a[116:119], v[220:223], v[116:119]
    v_mfma_f32_16x16x32_bf16 v[112:115], a[112:115], v[220:223], v[112:115]
    s_waitcnt vmcnt(35) lgkmcnt(3)
    v_mfma_f32_16x16x32_bf16 v[96:99], a[128:131], v[192:195], v[96:99]
    ds_read_b128 v[208:211], v25 offset:40960
    s_waitcnt vmcnt(34)
    v_mfma_f32_16x16x32_bf16 v[100:103], a[132:135], v[192:195], v[100:103]
    v_cvt_pk_bf16_f32 v144, v48, v49
    s_waitcnt vmcnt(33)
    v_mfma_f32_16x16x32_bf16 v[104:107], a[136:139], v[192:195], v[104:107]
    v_cvt_pk_bf16_f32 v148, v56, v57
    s_waitcnt vmcnt(32)
    v_mfma_f32_16x16x32_bf16 v[108:111], a[140:143], v[192:195], v[108:111]
    s_waitcnt lgkmcnt(3)
    v_mfma_f32_16x16x32_bf16 v[124:127], a[140:143], v[196:199], v[124:127]
    ds_read_b128 v[212:215], v25 offset:41216
    v_mfma_f32_16x16x32_bf16 v[120:123], a[136:139], v[196:199], v[120:123]
    v_cvt_pk_bf16_f32 v145, v50, v51
    v_mfma_f32_16x16x32_bf16 v[116:119], a[132:135], v[196:199], v[116:119]
    v_cvt_pk_bf16_f32 v149, v58, v59
    v_mfma_f32_16x16x32_bf16 v[112:115], a[128:131], v[196:199], v[112:115]
    s_waitcnt vmcnt(31) lgkmcnt(3)
    v_mfma_f32_16x16x32_bf16 v[96:99], a[144:147], v[200:203], v[96:99]
    ds_read_b128 v[216:219], v25 offset:45056
    s_waitcnt vmcnt(30)
    v_mfma_f32_16x16x32_bf16 v[100:103], a[148:151], v[200:203], v[100:103]
    v_cvt_pk_bf16_f32 v146, v52, v53
    s_waitcnt vmcnt(29)
    v_mfma_f32_16x16x32_bf16 v[104:107], a[152:155], v[200:203], v[104:107]
    v_cvt_pk_bf16_f32 v150, v60, v61
    s_waitcnt vmcnt(28)
    v_mfma_f32_16x16x32_bf16 v[108:111], a[156:159], v[200:203], v[108:111]
    s_waitcnt lgkmcnt(3)
    v_mfma_f32_16x16x32_bf16 v[124:127], a[156:159], v[204:207], v[124:127]
    ds_read_b128 v[220:223], v25 offset:45312
    v_mfma_f32_16x16x32_bf16 v[120:123], a[152:155], v[204:207], v[120:123]
    v_cvt_pk_bf16_f32 v147, v54, v55
    v_mfma_f32_16x16x32_bf16 v[116:119], a[148:151], v[204:207], v[116:119]
    v_mfma_f32_16x16x32_bf16 v[112:115], a[144:147], v[204:207], v[112:115]
    v_cvt_pk_bf16_f32 v151, v62, v63
    s_waitcnt vmcnt(27) lgkmcnt(3)
    v_mfma_f32_16x16x32_bf16 v[96:99], a[160:163], v[208:211], v[96:99]
    ds_read_b128 v[192:195], v25 offset:49152
    s_waitcnt vmcnt(26)
    v_mfma_f32_16x16x32_bf16 v[100:103], a[164:167], v[208:211], v[100:103]
    v_permlane16_swap_b32 v144, v148
    s_waitcnt vmcnt(25)
    v_mfma_f32_16x16x32_bf16 v[104:107], a[168:171], v[208:211], v[104:107]
    s_waitcnt vmcnt(24)
    v_mfma_f32_16x16x32_bf16 v[108:111], a[172:175], v[208:211], v[108:111]
    v_permlane16_swap_b32 v145, v149
    s_waitcnt lgkmcnt(3)
    v_mfma_f32_16x16x32_bf16 v[124:127], a[172:175], v[212:215], v[124:127]
    ds_read_b128 v[196:199], v25 offset:49408
    v_mfma_f32_16x16x32_bf16 v[120:123], a[168:171], v[212:215], v[120:123]
    v_permlane16_swap_b32 v146, v150
    v_mfma_f32_16x16x32_bf16 v[116:119], a[164:167], v[212:215], v[116:119]
    v_mfma_f32_16x16x32_bf16 v[112:115], a[160:163], v[212:215], v[112:115]
    v_permlane16_swap_b32 v147, v151
    s_waitcnt vmcnt(23) lgkmcnt(3)
    v_mfma_f32_16x16x32_bf16 v[96:99], a[176:179], v[216:219], v[96:99]
    ds_read_b128 v[200:203], v25 offset:53248
    s_waitcnt vmcnt(22)
    v_mfma_f32_16x16x32_bf16 v[100:103], a[180:183], v[216:219], v[100:103]
    buffer_store_dwordx4 v[144:147], v16, s[48:51], s101 offen offset:0 sc1
    s_waitcnt vmcnt(22)
    v_mfma_f32_16x16x32_bf16 v[104:107], a[184:187], v[216:219], v[104:107]
    s_waitcnt vmcnt(21)
    v_mfma_f32_16x16x32_bf16 v[108:111], a[188:191], v[216:219], v[108:111]
    buffer_store_dwordx4 v[148:151], v18, s[48:51], s6 offen offset:0 sc1
    s_waitcnt lgkmcnt(3)
    v_mfma_f32_16x16x32_bf16 v[124:127], a[188:191], v[220:223], v[124:127]
    ds_read_b128 v[204:207], v25 offset:53504
    v_mfma_f32_16x16x32_bf16 v[120:123], a[184:187], v[220:223], v[120:123]
    v_mfma_f32_16x16x32_bf16 v[116:119], a[180:183], v[220:223], v[116:119]
    v_cvt_pk_bf16_f32 v152, v80, v81
    v_mfma_f32_16x16x32_bf16 v[112:115], a[176:179], v[220:223], v[112:115]
    s_waitcnt vmcnt(21) lgkmcnt(3)
    v_mfma_f32_16x16x32_bf16 v[96:99], a[192:195], v[192:195], v[96:99]
    ds_read_b128 v[208:211], v25 offset:57344
    s_waitcnt vmcnt(20)
    v_mfma_f32_16x16x32_bf16 v[100:103], a[196:199], v[192:195], v[100:103]
    v_cvt_pk_bf16_f32 v156, v88, v89
    s_waitcnt vmcnt(19)
    v_mfma_f32_16x16x32_bf16 v[104:107], a[200:203], v[192:195], v[104:107]
    v_cvt_pk_bf16_f32 v153, v82, v83
    s_waitcnt vmcnt(18)
    v_mfma_f32_16x16x32_bf16 v[108:111], a[204:207], v[192:195], v[108:111]
    s_waitcnt lgkmcnt(3)
    v_mfma_f32_16x16x32_bf16 v[124:127], a[204:207], v[196:199], v[124:127]
    ds_read_b128 v[212:215], v25 offset:57600
    v_mfma_f32_16x16x32_bf16 v[120:123], a[200:203], v[196:199], v[120:123]
    v_cvt_pk_bf16_f32 v157, v90, v91
    v_mfma_f32_16x16x32_bf16 v[116:119], a[196:199], v[196:199], v[116:119]
    v_cvt_pk_bf16_f32 v154, v84, v85
    v_mfma_f32_16x16x32_bf16 v[112:115], a[192:195], v[196:199], v[112:115]
    s_waitcnt vmcnt(17) lgkmcnt(3)
    v_mfma_f32_16x16x32_bf16 v[96:99], a[208:211], v[200:203], v[96:99]
    ds_read_b128 v[216:219], v25 offset:61440
    s_waitcnt vmcnt(16)
    v_mfma_f32_16x16x32_bf16 v[100:103], a[212:215], v[200:203], v[100:103]
    v_cvt_pk_bf16_f32 v158, v92, v93
    s_waitcnt vmcnt(15)
    v_mfma_f32_16x16x32_bf16 v[104:107], a[216:219], v[200:203], v[104:107]
    v_cvt_pk_bf16_f32 v155, v86, v87
    s_waitcnt vmcnt(14)
    v_mfma_f32_16x16x32_bf16 v[108:111], a[220:223], v[200:203], v[108:111]
    s_waitcnt lgkmcnt(3)
    v_mfma_f32_16x16x32_bf16 v[124:127], a[220:223], v[204:207], v[124:127]
    ds_read_b128 v[220:223], v25 offset:61696
    v_mfma_f32_16x16x32_bf16 v[120:123], a[216:219], v[204:207], v[120:123]
    v_cvt_pk_bf16_f32 v159, v94, v95
    v_mfma_f32_16x16x32_bf16 v[116:119], a[212:215], v[204:207], v[116:119]
    v_mfma_f32_16x16x32_bf16 v[112:115], a[208:211], v[204:207], v[112:115]
    v_permlane16_swap_b32 v152, v156
    s_waitcnt vmcnt(13) lgkmcnt(3)
    v_mfma_f32_16x16x32_bf16 v[96:99], a[224:227], v[208:211], v[96:99]
    ds_read_b128 v[192:195], v25 offset:512
    s_waitcnt vmcnt(12)
    v_mfma_f32_16x16x32_bf16 v[100:103], a[228:231], v[208:211], v[100:103]
    v_permlane16_swap_b32 v153, v157
    s_waitcnt vmcnt(11)
    v_mfma_f32_16x16x32_bf16 v[104:107], a[232:235], v[208:211], v[104:107]
    s_waitcnt vmcnt(10)
    v_mfma_f32_16x16x32_bf16 v[108:111], a[236:239], v[208:211], v[108:111]
    v_permlane16_swap_b32 v154, v158
    s_waitcnt lgkmcnt(3)
    v_mfma_f32_16x16x32_bf16 v[124:127], a[236:239], v[212:215], v[124:127]
    ds_read_b128 v[196:199], v25 offset:4608
    v_mfma_f32_16x16x32_bf16 v[120:123], a[232:235], v[212:215], v[120:123]
    v_permlane16_swap_b32 v155, v159
    v_mfma_f32_16x16x32_bf16 v[116:119], a[228:231], v[212:215], v[116:119]
    v_mfma_f32_16x16x32_bf16 v[112:115], a[224:227], v[212:215], v[112:115]
    buffer_store_dwordx4 v[152:155], v16, s[48:51], s101 offen offset:64 sc1
    s_waitcnt vmcnt(10) lgkmcnt(3)
    v_mfma_f32_16x16x32_bf16 v[96:99], a[240:243], v[216:219], v[96:99]
    ds_read_b128 v[200:203], v25 offset:8704
    s_waitcnt vmcnt(9)
    v_mfma_f32_16x16x32_bf16 v[100:103], a[244:247], v[216:219], v[100:103]
    buffer_store_dwordx4 v[156:159], v18, s[48:51], s6 offen offset:64 sc1
    s_waitcnt vmcnt(9)
    v_mfma_f32_16x16x32_bf16 v[104:107], a[248:251], v[216:219], v[104:107]
    s_waitcnt vmcnt(8)
    v_mfma_f32_16x16x32_bf16 v[108:111], a[252:255], v[216:219], v[108:111]
    s_waitcnt lgkmcnt(3)
    v_mfma_f32_16x16x32_bf16 v[124:127], a[252:255], v[220:223], v[124:127]
    ds_read_b128 v[204:207], v25 offset:12800
    v_mfma_f32_16x16x32_bf16 v[120:123], a[248:251], v[220:223], v[120:123]
    v_mfma_f32_16x16x32_bf16 v[116:119], a[244:247], v[220:223], v[116:119]
    v_mfma_f32_16x16x32_bf16 v[112:115], a[240:243], v[220:223], v[112:115]
    s_waitcnt lgkmcnt(3)
    v_mfma_f32_16x16x32_bf16 v[32:35], a[0:3], v[192:195], 0
    ds_read_b128 v[208:211], v25 offset:16896
    v_mfma_f32_16x16x32_bf16 v[36:39], a[4:7], v[192:195], 0
    v_mfma_f32_16x16x32_bf16 v[40:43], a[8:11], v[192:195], 0
    v_cvt_pk_bf16_f32 v168, v96, v97
    v_mfma_f32_16x16x32_bf16 v[44:47], a[12:15], v[192:195], 0
    s_waitcnt lgkmcnt(3)
    v_mfma_f32_16x16x32_bf16 v[44:47], a[28:31], v[196:199], v[44:47]
    ds_read_b128 v[212:215], v25 offset:20992
    v_mfma_f32_16x16x32_bf16 v[40:43], a[24:27], v[196:199], v[40:43]
    v_cvt_pk_bf16_f32 v169, v98, v99
    v_mfma_f32_16x16x32_bf16 v[36:39], a[20:23], v[196:199], v[36:39]
    v_mfma_f32_16x16x32_bf16 v[32:35], a[16:19], v[196:199], v[32:35]
    s_waitcnt lgkmcnt(3)
    v_mfma_f32_16x16x32_bf16 v[32:35], a[32:35], v[200:203], v[32:35]
    ds_read_b128 v[216:219], v25 offset:25088
    v_mfma_f32_16x16x32_bf16 v[36:39], a[36:39], v[200:203], v[36:39]
    v_cvt_pk_bf16_f32 v170, v100, v101
    v_mfma_f32_16x16x32_bf16 v[40:43], a[40:43], v[200:203], v[40:43]
    v_mfma_f32_16x16x32_bf16 v[44:47], a[44:47], v[200:203], v[44:47]
    v_cvt_pk_bf16_f32 v171, v102, v103
    s_waitcnt lgkmcnt(3)
    v_mfma_f32_16x16x32_bf16 v[44:47], a[60:63], v[204:207], v[44:47]
    ds_read_b128 v[220:223], v25 offset:29184
    v_mfma_f32_16x16x32_bf16 v[40:43], a[56:59], v[204:207], v[40:43]
    v_mfma_f32_16x16x32_bf16 v[36:39], a[52:55], v[204:207], v[36:39]
    buffer_store_dwordx4 v[168:171], v17, s[48:51], 0 offen offset:512 sc1
    v_mfma_f32_16x16x32_bf16 v[32:35], a[48:51], v[204:207], v[32:35]
    s_waitcnt lgkmcnt(3)
    v_mfma_f32_16x16x32_bf16 v[32:35], a[64:67], v[208:211], v[32:35]
    ds_read_b128 v[192:195], v25 offset:33280
    v_mfma_f32_16x16x32_bf16 v[36:39], a[68:71], v[208:211], v[36:39]
    v_cvt_pk_bf16_f32 v172, v104, v105
    v_mfma_f32_16x16x32_bf16 v[40:43], a[72:75], v[208:211], v[40:43]
    v_mfma_f32_16x16x32_bf16 v[44:47], a[76:79], v[208:211], v[44:47]
    s_waitcnt lgkmcnt(3)
    v_mfma_f32_16x16x32_bf16 v[44:47], a[92:95], v[212:215], v[44:47]
    ds_read_b128 v[196:199], v25 offset:37376
    v_mfma_f32_16x16x32_bf16 v[40:43], a[88:91], v[212:215], v[40:43]
    v_cvt_pk_bf16_f32 v173, v106, v107
    v_mfma_f32_16x16x32_bf16 v[36:39], a[84:87], v[212:215], v[36:39]
    v_mfma_f32_16x16x32_bf16 v[32:35], a[80:83], v[212:215], v[32:35]
    v_cvt_pk_bf16_f32 v174, v108, v109
    s_waitcnt lgkmcnt(3)
    v_mfma_f32_16x16x32_bf16 v[32:35], a[96:99], v[216:219], v[32:35]
    ds_read_b128 v[200:203], v25 offset:41472
    v_mfma_f32_16x16x32_bf16 v[36:39], a[100:103], v[216:219], v[36:39]
    v_mfma_f32_16x16x32_bf16 v[40:43], a[104:107], v[216:219], v[40:43]
    v_cvt_pk_bf16_f32 v175, v110, v111
    v_mfma_f32_16x16x32_bf16 v[44:47], a[108:111], v[216:219], v[44:47]
    s_waitcnt lgkmcnt(3)
    v_mfma_f32_16x16x32_bf16 v[44:47], a[124:127], v[220:223], v[44:47]
    ds_read_b128 v[204:207], v25 offset:45568
    v_mfma_f32_16x16x32_bf16 v[40:43], a[120:123], v[220:223], v[40:43]
    buffer_store_dwordx4 v[172:175], v21, s[48:51], 0 offen offset:512 sc1
    v_mfma_f32_16x16x32_bf16 v[36:39], a[116:119], v[220:223], v[36:39]
    v_mfma_f32_16x16x32_bf16 v[32:35], a[112:115], v[220:223], v[32:35]
    s_waitcnt lgkmcnt(3)
    v_mfma_f32_16x16x32_bf16 v[32:35], a[128:131], v[192:195], v[32:35]
    ds_read_b128 v[208:211], v25 offset:49664
    v_mfma_f32_16x16x32_bf16 v[36:39], a[132:135], v[192:195], v[36:39]
    v_cvt_pk_bf16_f32 v176, v112, v113
    v_mfma_f32_16x16x32_bf16 v[40:43], a[136:139], v[192:195], v[40:43]
    v_mfma_f32_16x16x32_bf16 v[44:47], a[140:143], v[192:195], v[44:47]
    v_cvt_pk_bf16_f32 v177, v114, v115
    s_waitcnt lgkmcnt(3)
    v_mfma_f32_16x16x32_bf16 v[44:47], a[156:159], v[196:199], v[44:47]
    ds_read_b128 v[212:215], v25 offset:53760
    v_mfma_f32_16x16x32_bf16 v[40:43], a[152:155], v[196:199], v[40:43]
    v_mfma_f32_16x16x32_bf16 v[36:39], a[148:151], v[196:199], v[36:39]
    v_cvt_pk_bf16_f32 v178, v116, v117
    v_mfma_f32_16x16x32_bf16 v[32:35], a[144:147], v[196:199], v[32:35]
    s_waitcnt lgkmcnt(3)
    v_mfma_f32_16x16x32_bf16 v[32:35], a[160:163], v[200:203], v[32:35]
    ds_read_b128 v[216:219], v25 offset:57856
    v_mfma_f32_16x16x32_bf16 v[36:39], a[164:167], v[200:203], v[36:39]
    v_cvt_pk_bf16_f32 v179, v118, v119
    v_mfma_f32_16x16x32_bf16 v[40:43], a[168:171], v[200:203], v[40:43]
    v_mfma_f32_16x16x32_bf16 v[44:47], a[172:175], v[200:203], v[44:47]
    s_waitcnt lgkmcnt(3)
    v_mfma_f32_16x16x32_bf16 v[44:47], a[188:191], v[204:207], v[44:47]
    ds_read_b128 v[220:223], v25 offset:61952
    v_mfma_f32_16x16x32_bf16 v[40:43], a[184:187], v[204:207], v[40:43]
    buffer_store_dwordx4 v[176:179], v17, s[48:51], s100 offen offset:512 sc1
    v_mfma_f32_16x16x32_bf16 v[36:39], a[180:183], v[204:207], v[36:39]
    v_mfma_f32_16x16x32_bf16 v[32:35], a[176:179], v[204:207], v[32:35]
    v_cvt_pk_bf16_f32 v180, v120, v121
    s_waitcnt lgkmcnt(3)
    v_mfma_f32_16x16x32_bf16 v[32:35], a[192:195], v[208:211], v[32:35]
    ds_read_b128 v[192:195], v25 offset:768
    v_mfma_f32_16x16x32_bf16 v[36:39], a[196:199], v[208:211], v[36:39]
    v_mfma_f32_16x16x32_bf16 v[40:43], a[200:203], v[208:211], v[40:43]
    v_cvt_pk_bf16_f32 v181, v122, v123
    v_mfma_f32_16x16x32_bf16 v[44:47], a[204:207], v[208:211], v[44:47]
    s_waitcnt lgkmcnt(3)
    v_mfma_f32_16x16x32_bf16 v[44:47], a[220:223], v[212:215], v[44:47]
    ds_read_b128 v[196:199], v25 offset:4864
    v_mfma_f32_16x16x32_bf16 v[40:43], a[216:219], v[212:215], v[40:43]
    v_cvt_pk_bf16_f32 v182, v124, v125
    v_mfma_f32_16x16x32_bf16 v[36:39], a[212:215], v[212:215], v[36:39]
    v_mfma_f32_16x16x32_bf16 v[32:35], a[208:211], v[212:215], v[32:35]
    s_waitcnt lgkmcnt(3)
    v_mfma_f32_16x16x32_bf16 v[32:35], a[224:227], v[216:219], v[32:35]
    ds_read_b128 v[200:203], v25 offset:8960
    v_mfma_f32_16x16x32_bf16 v[36:39], a[228:231], v[216:219], v[36:39]
    v_cvt_pk_bf16_f32 v183, v126, v127
    v_mfma_f32_16x16x32_bf16 v[40:43], a[232:235], v[216:219], v[40:43]
    v_mfma_f32_16x16x32_bf16 v[44:47], a[236:239], v[216:219], v[44:47]
    buffer_store_dwordx4 v[180:183], v21, s[48:51], s100 offen offset:512 sc1
    s_waitcnt lgkmcnt(3)
    v_mfma_f32_16x16x32_bf16 v[44:47], a[252:255], v[220:223], v[44:47]
    ds_read_b128 v[204:207], v25 offset:13056
    v_mfma_f32_16x16x32_bf16 v[40:43], a[248:251], v[220:223], v[40:43]
    v_mfma_f32_16x16x32_bf16 v[36:39], a[244:247], v[220:223], v[36:39]
    v_mfma_f32_16x16x32_bf16 v[32:35], a[240:243], v[220:223], v[32:35]
    s_waitcnt lgkmcnt(3)
    v_mfma_f32_16x16x32_bf16 v[48:51], a[0:3], v[192:195], 0
    ds_read_b128 v[208:211], v25 offset:17152
    v_mfma_f32_16x16x32_bf16 v[52:55], a[4:7], v[192:195], 0
    s_waitcnt lgkmcnt(3)
    v_mfma_f32_16x16x32_bf16 v[52:55], a[20:23], v[196:199], v[52:55]
    ds_read_b128 v[212:215], v25 offset:21248
    v_mfma_f32_16x16x32_bf16 v[48:51], a[16:19], v[196:199], v[48:51]
    v_cvt_pk_bf16_f32 v184, v32, v33
    s_waitcnt lgkmcnt(3)
    v_mfma_f32_16x16x32_bf16 v[48:51], a[32:35], v[200:203], v[48:51]
    ds_read_b128 v[216:219], v25 offset:25344
    v_mfma_f32_16x16x32_bf16 v[52:55], a[36:39], v[200:203], v[52:55]
    v_cvt_pk_bf16_f32 v185, v34, v35
    s_waitcnt lgkmcnt(3)
    v_mfma_f32_16x16x32_bf16 v[52:55], a[52:55], v[204:207], v[52:55]
    ds_read_b128 v[220:223], v25 offset:29440
    v_mfma_f32_16x16x32_bf16 v[48:51], a[48:51], v[204:207], v[48:51]
    v_cvt_pk_bf16_f32 v186, v36, v37
    s_waitcnt lgkmcnt(3)
    v_mfma_f32_16x16x32_bf16 v[48:51], a[64:67], v[208:211], v[48:51]
    ds_read_b128 v[192:195], v25 offset:33536
    v_mfma_f32_16x16x32_bf16 v[52:55], a[68:71], v[208:211], v[52:55]
    s_waitcnt lgkmcnt(3)
    v_mfma_f32_16x16x32_bf16 v[52:55], a[84:87], v[212:215], v[52:55]
    ds_read_b128 v[196:199], v25 offset:37632
    v_mfma_f32_16x16x32_bf16 v[48:51], a[80:83], v[212:215], v[48:51]
    v_cvt_pk_bf16_f32 v187, v38, v39
    s_waitcnt lgkmcnt(3)
    v_mfma_f32_16x16x32_bf16 v[48:51], a[96:99], v[216:219], v[48:51]
    ds_read_b128 v[200:203], v25 offset:41728
    v_mfma_f32_16x16x32_bf16 v[52:55], a[100:103], v[216:219], v[52:55]
    buffer_store_dwordx4 v[184:187], v17, s[48:51], s101 offen offset:512 sc1
    s_waitcnt lgkmcnt(3)
    v_mfma_f32_16x16x32_bf16 v[52:55], a[116:119], v[220:223], v[52:55]
    ds_read_b128 v[204:207], v25 offset:45824
    v_mfma_f32_16x16x32_bf16 v[48:51], a[112:115], v[220:223], v[48:51]
    s_waitcnt lgkmcnt(3)
    v_mfma_f32_16x16x32_bf16 v[48:51], a[128:131], v[192:195], v[48:51]
    ds_read_b128 v[208:211], v25 offset:49920
    v_mfma_f32_16x16x32_bf16 v[52:55], a[132:135], v[192:195], v[52:55]
    v_cvt_pk_bf16_f32 v188, v40, v41
    s_waitcnt lgkmcnt(3)
    v_mfma_f32_16x16x32_bf16 v[52:55], a[148:151], v[196:199], v[52:55]
    ds_read_b128 v[212:215], v25 offset:54016
    v_mfma_f32_16x16x32_bf16 v[48:51], a[144:147], v[196:199], v[48:51]
    v_cvt_pk_bf16_f32 v189, v42, v43
    s_waitcnt lgkmcnt(3)
    v_mfma_f32_16x16x32_bf16 v[48:51], a[160:163], v[200:203], v[48:51]
    ds_read_b128 v[216:219], v25 offset:58112
    v_mfma_f32_16x16x32_bf16 v[52:55], a[164:167], v[200:203], v[52:55]
    v_cvt_pk_bf16_f32 v190, v44, v45
    s_waitcnt lgkmcnt(3)
    v_mfma_f32_16x16x32_bf16 v[52:55], a[180:183], v[204:207], v[52:55]
    ds_read_b128 v[220:223], v25 offset:62208
    v_mfma_f32_16x16x32_bf16 v[48:51], a[176:179], v[204:207], v[48:51]
    s_waitcnt lgkmcnt(3)
    v_mfma_f32_16x16x32_bf16 v[48:51], a[192:195], v[208:211], v[48:51]
    ds_read_b128 v[192:195], v25 offset:768
    v_mfma_f32_16x16x32_bf16 v[52:55], a[196:199], v[208:211], v[52:55]
    v_cvt_pk_bf16_f32 v191, v46, v47
    s_waitcnt lgkmcnt(3)
    v_mfma_f32_16x16x32_bf16 v[52:55], a[212:215], v[212:215], v[52:55]
    ds_read_b128 v[196:199], v25 offset:4864
    v_mfma_f32_16x16x32_bf16 v[48:51], a[208:211], v[212:215], v[48:51]
    buffer_store_dwordx4 v[188:191], v21, s[48:51], s101 offen offset:512 sc1
    s_waitcnt lgkmcnt(3)
    v_mfma_f32_16x16x32_bf16 v[48:51], a[224:227], v[216:219], v[48:51]
    ds_read_b128 v[200:203], v25 offset:8960
    v_mfma_f32_16x16x32_bf16 v[52:55], a[228:231], v[216:219], v[52:55]
    s_waitcnt lgkmcnt(3)
    v_mfma_f32_16x16x32_bf16 v[52:55], a[244:247], v[220:223], v[52:55]
    ds_read_b128 v[204:207], v25 offset:13056
    v_mfma_f32_16x16x32_bf16 v[48:51], a[240:243], v[220:223], v[48:51]
    s_waitcnt lgkmcnt(3)
    v_mfma_f32_16x16x32_bf16 v[56:59], a[8:11], v[192:195], 0
    ds_read_b128 v[208:211], v25 offset:17152
    v_mfma_f32_16x16x32_bf16 v[60:63], a[12:15], v[192:195], 0
    s_waitcnt lgkmcnt(3)
    v_mfma_f32_16x16x32_bf16 v[60:63], a[28:31], v[196:199], v[60:63]
    ds_read_b128 v[212:215], v25 offset:21248
    v_mfma_f32_16x16x32_bf16 v[56:59], a[24:27], v[196:199], v[56:59]
    v_cvt_pk_bf16_f32 v160, v48, v49
    s_waitcnt lgkmcnt(3)
    v_mfma_f32_16x16x32_bf16 v[56:59], a[40:43], v[200:203], v[56:59]
    ds_read_b128 v[216:219], v25 offset:25344
    v_mfma_f32_16x16x32_bf16 v[60:63], a[44:47], v[200:203], v[60:63]
    s_waitcnt lgkmcnt(3)
    v_mfma_f32_16x16x32_bf16 v[60:63], a[60:63], v[204:207], v[60:63]
    ds_read_b128 v[220:223], v25 offset:29440
    v_mfma_f32_16x16x32_bf16 v[56:59], a[56:59], v[204:207], v[56:59]
    v_cvt_pk_bf16_f32 v161, v50, v51
    s_waitcnt lgkmcnt(3)
    v_mfma_f32_16x16x32_bf16 v[56:59], a[72:75], v[208:211], v[56:59]
    ds_read_b128 v[192:195], v25 offset:33536
    v_mfma_f32_16x16x32_bf16 v[60:63], a[76:79], v[208:211], v[60:63]
    s_waitcnt lgkmcnt(3)
    v_mfma_f32_16x16x32_bf16 v[60:63], a[92:95], v[212:215], v[60:63]
    ds_read_b128 v[196:199], v25 offset:37632
    v_mfma_f32_16x16x32_bf16 v[56:59], a[88:91], v[212:215], v[56:59]
    v_cvt_pk_bf16_f32 v162, v52, v53
    s_waitcnt lgkmcnt(3)
    v_mfma_f32_16x16x32_bf16 v[56:59], a[104:107], v[216:219], v[56:59]
    ds_read_b128 v[200:203], v25 offset:41728
    v_mfma_f32_16x16x32_bf16 v[60:63], a[108:111], v[216:219], v[60:63]
    s_waitcnt lgkmcnt(3)
    v_mfma_f32_16x16x32_bf16 v[60:63], a[124:127], v[220:223], v[60:63]
    ds_read_b128 v[204:207], v25 offset:45824
    v_mfma_f32_16x16x32_bf16 v[56:59], a[120:123], v[220:223], v[56:59]
    v_cvt_pk_bf16_f32 v163, v54, v55
    s_waitcnt lgkmcnt(3)
    v_mfma_f32_16x16x32_bf16 v[56:59], a[136:139], v[192:195], v[56:59]
    ds_read_b128 v[208:211], v25 offset:49920
    v_mfma_f32_16x16x32_bf16 v[60:63], a[140:143], v[192:195], v[60:63]
    s_waitcnt lgkmcnt(3)
    v_mfma_f32_16x16x32_bf16 v[60:63], a[156:159], v[196:199], v[60:63]
    ds_read_b128 v[212:215], v25 offset:54016
    v_mfma_f32_16x16x32_bf16 v[56:59], a[152:155], v[196:199], v[56:59]
    buffer_store_dwordx4 v[160:163], v19, s[48:51], s6 offen offset:512 sc1
    s_waitcnt lgkmcnt(3)
    v_mfma_f32_16x16x32_bf16 v[56:59], a[168:171], v[200:203], v[56:59]
    ds_read_b128 v[216:219], v25 offset:58112
    v_mfma_f32_16x16x32_bf16 v[60:63], a[172:175], v[200:203], v[60:63]
    s_waitcnt lgkmcnt(3)
    v_mfma_f32_16x16x32_bf16 v[60:63], a[188:191], v[204:207], v[60:63]
    ds_read_b128 v[220:223], v25 offset:62208
    v_mfma_f32_16x16x32_bf16 v[56:59], a[184:187], v[204:207], v[56:59]
    s_waitcnt lgkmcnt(3)
    v_mfma_f32_16x16x32_bf16 v[56:59], a[200:203], v[208:211], v[56:59]
    v_mfma_f32_16x16x32_bf16 v[60:63], a[204:207], v[208:211], v[60:63]
    s_waitcnt lgkmcnt(2)
    v_mfma_f32_16x16x32_bf16 v[60:63], a[220:223], v[212:215], v[60:63]
    v_mfma_f32_16x16x32_bf16 v[56:59], a[216:219], v[212:215], v[56:59]
    s_waitcnt lgkmcnt(1)
    v_mfma_f32_16x16x32_bf16 v[56:59], a[232:235], v[216:219], v[56:59]
    v_mfma_f32_16x16x32_bf16 v[60:63], a[236:239], v[216:219], v[60:63]
    s_waitcnt lgkmcnt(0)
    v_mfma_f32_16x16x32_bf16 v[60:63], a[252:255], v[220:223], v[60:63]
    v_mfma_f32_16x16x32_bf16 v[56:59], a[248:251], v[220:223], v[56:59]
    s_nop 7
    v_cvt_pk_bf16_f32 v164, v56, v57
    v_cvt_pk_bf16_f32 v165, v58, v59
    v_cvt_pk_bf16_f32 v166, v60, v61
    v_cvt_pk_bf16_f32 v167, v62, v63
    buffer_store_dwordx4 v[164:167], v22, s[48:51], s6 offen offset:512 sc1
L_END:
    s_endpgm
L_SLOW:
    s_waitcnt vmcnt(0) lgkmcnt(0)
    s_barrier
    buffer_load_dwordx4 v[104:107], v15, s[44:47], s8 offen sc1
    buffer_load_dwordx4 v[108:111], v15, s[44:47], s85 offen sc1
    buffer_load_dwordx4 v[112:115], v2, s[44:47], s7 offen offset:0 sc1
    buffer_load_dwordx4 v[116:119], v2, s[44:47], s7 offen offset:1024 sc1
    buffer_load_dwordx4 v[120:123], v2, s[44:47], s7 offen offset:2048 sc1
    buffer_load_dwordx4 v[124:127], v2, s[44:47], s7 offen offset:3072 sc1
    s_waitcnt vmcnt(0)
    v_lshlrev_b32 v208, 16, v104
    v_and_b32 v209, 0xffff0000, v104
    v_lshlrev_b32 v210, 16, v105
    v_and_b32 v211, 0xffff0000, v105
    v_lshlrev_b32 v212, 16, v106
    v_and_b32 v213, 0xffff0000, v106
    v_lshlrev_b32 v214, 16, v107
    v_and_b32 v215, 0xffff0000, v107
    v_pk_fma_f32 v[208:209], v[208:209], v[10:11], v[10:11] op_sel:[0,0,1] op_sel_hi:[1,0,1]
    v_pk_fma_f32 v[210:211], v[210:211], v[10:11], v[10:11] op_sel:[0,0,1] op_sel_hi:[1,0,1]
    v_pk_fma_f32 v[212:213], v[212:213], v[10:11], v[10:11] op_sel:[0,0,1] op_sel_hi:[1,0,1]
    v_pk_fma_f32 v[214:215], v[214:215], v[10:11], v[10:11] op_sel:[0,0,1] op_sel_hi:[1,0,1]
    ds_write_b128 v14, v[208:211] offset:0
    ds_write_b128 v14, v[212:215] offset:16
    v_lshlrev_b32 v216, 16, v108
    v_and_b32 v217, 0xffff0000, v108
    v_lshlrev_b32 v218, 16, v109
    v_and_b32 v219, 0xffff0000, v109
    v_lshlrev_b32 v220, 16, v110
    v_and_b32 v221, 0xffff0000, v110
    v_lshlrev_b32 v222, 16, v111
    v_and_b32 v223, 0xffff0000, v111
    v_pk_fma_f32 v[216:217], v[216:217], v[10:11], v[10:11] op_sel:[0,0,1] op_sel_hi:[1,0,1]
    v_pk_fma_f32 v[218:219], v[218:219], v[10:11], v[10:11] op_sel:[0,0,1] op_sel_hi:[1,0,1]
    v_pk_fma_f32 v[220:221], v[220:221], v[10:11], v[10:11] op_sel:[0,0,1] op_sel_hi:[1,0,1]
    v_pk_fma_f32 v[222:223], v[222:223], v[10:11], v[10:11] op_sel:[0,0,1] op_sel_hi:[1,0,1]
    ds_write_b128 v20, v[216:219] offset:0
    ds_write_b128 v20, v[220:223] offset:16
    ds_write_b128 v27, v[112:115] offset:0
    ds_write_b128 v27, v[116:119] offset:1024
    ds_write_b128 v23, v[120:123] offset:0
    ds_write_b128 v23, v[124:127] offset:1024
    s_waitcnt lgkmcnt(0)
    s_barrier
    ds_read_b128 v[128:131], v26 offset:0
    ds_read_b128 v[132:135], v26 offset:128
    s_waitcnt lgkmcnt(0)
    ds_read_b128 v[136:139], v26 offset:2048
    ds_read_b128 v[140:143], v26 offset:2176
    s_waitcnt lgkmcnt(0)
    ds_read_b128 v[144:147], v26 offset:4096
    ds_read_b128 v[148:151], v26 offset:4224
    s_waitcnt lgkmcnt(0)
    ds_read_b128 v[152:155], v26 offset:6144
    ds_read_b128 v[156:159], v26 offset:6272
    s_waitcnt lgkmcnt(0)
    ds_read_b128 v[160:163], v26 offset:8192
    ds_read_b128 v[164:167], v26 offset:8320
    s_waitcnt lgkmcnt(0)
    ds_read_b128 v[168:171], v26 offset:10240
    ds_read_b128 v[172:175], v26 offset:10368
    s_waitcnt lgkmcnt(0)
    ds_read_b128 v[176:179], v26 offset:12288
    ds_read_b128 v[180:183], v26 offset:12416
    s_waitcnt lgkmcnt(0)
    ds_read_b128 v[184:187], v26 offset:14336
    ds_read_b128 v[188:191], v26 offset:14464
    s_waitcnt lgkmcnt(0)
    ds_read_b128 v[224:227], v12 offset:0
    ds_read_b128 v[228:231], v12 offset:16
    s_waitcnt lgkmcnt(0)
    v_add_f32 v224, v224, v128
    v_add_f32 v225, v225, v129
    v_add_f32 v226, v226, v130
    v_add_f32 v227, v227, v131
    v_add_f32 v228, v228, v132
    v_add_f32 v229, v229, v133
    v_add_f32 v230, v230, v134
    v_add_f32 v231, v231, v135
    v_exp_f32 v224, v224
    v_exp_f32 v225, v225
    v_exp_f32 v226, v226
    v_exp_f32 v227, v227
    v_exp_f32 v228, v228
    v_exp_f32 v229, v229
    v_exp_f32 v230, v230
    v_exp_f32 v231, v231
    v_add_f32 v224, 0.5, v224
    v_add_f32 v225, 0.5, v225
    v_add_f32 v226, 0.5, v226
    v_add_f32 v227, 0.5, v227
    v_add_f32 v228, 0.5, v228
    v_add_f32 v229, 0.5, v229
    v_add_f32 v230, 0.5, v230
    v_add_f32 v231, 0.5, v231
    v_rcp_f32 v224, v224
    v_rcp_f32 v225, v225
    v_rcp_f32 v226, v226
    v_rcp_f32 v227, v227
    v_rcp_f32 v228, v228
    v_rcp_f32 v229, v229
    v_rcp_f32 v230, v230
    v_rcp_f32 v231, v231
    v_sub_f32 v224, 1.0, v224
    v_sub_f32 v225, 1.0, v225
    v_sub_f32 v226, 1.0, v226
    v_sub_f32 v227, 1.0, v227
    v_sub_f32 v228, 1.0, v228
    v_sub_f32 v229, 1.0, v229
    v_sub_f32 v230, 1.0, v230
    v_sub_f32 v231, 1.0, v231
    v_cvt_pk_bf16_f32 v240, v224, v225
    v_cvt_pk_bf16_f32 v241, v226, v227
    v_cvt_pk_bf16_f32 v242, v228, v229
    v_cvt_pk_bf16_f32 v243, v230, v231
    ds_write_b128 v13, v[240:243] offset:0
    ds_read_b128 v[224:227], v12 offset:2064
    ds_read_b128 v[228:231], v12 offset:2080
    s_waitcnt lgkmcnt(0)
    v_add_f32 v224, v224, v128
    v_add_f32 v225, v225, v129
    v_add_f32 v226, v226, v130
    v_add_f32 v227, v227, v131
    v_add_f32 v228, v228, v132
    v_add_f32 v229, v229, v133
    v_add_f32 v230, v230, v134
    v_add_f32 v231, v231, v135
    v_exp_f32 v224, v224
    v_exp_f32 v225, v225
    v_exp_f32 v226, v226
    v_exp_f32 v227, v227
    v_exp_f32 v228, v228
    v_exp_f32 v229, v229
    v_exp_f32 v230, v230
    v_exp_f32 v231, v231
    v_add_f32 v224, 0.5, v224
    v_add_f32 v225, 0.5, v225
    v_add_f32 v226, 0.5, v226
    v_add_f32 v227, 0.5, v227
    v_add_f32 v228, 0.5, v228
    v_add_f32 v229, 0.5, v229
    v_add_f32 v230, 0.5, v230
    v_add_f32 v231, 0.5, v231
    v_rcp_f32 v224, v224
    v_rcp_f32 v225, v225
    v_rcp_f32 v226, v226
    v_rcp_f32 v227, v227
    v_rcp_f32 v228, v228
    v_rcp_f32 v229, v229
    v_rcp_f32 v230, v230
    v_rcp_f32 v231, v231
    v_sub_f32 v224, 1.0, v224
    v_sub_f32 v225, 1.0, v225
    v_sub_f32 v226, 1.0, v226
    v_sub_f32 v227, 1.0, v227
    v_sub_f32 v228, 1.0, v228
    v_sub_f32 v229, 1.0, v229
    v_sub_f32 v230, 1.0, v230
    v_sub_f32 v231, 1.0, v231
    v_cvt_pk_bf16_f32 v240, v224, v225
    v_cvt_pk_bf16_f32 v241, v226, v227
    v_cvt_pk_bf16_f32 v242, v228, v229
    v_cvt_pk_bf16_f32 v243, v230, v231
    ds_write_b128 v13, v[240:243] offset:128
    ds_read_b128 v[224:227], v12 offset:256
    ds_read_b128 v[228:231], v12 offset:272
    s_waitcnt lgkmcnt(0)
    v_add_f32 v224, v224, v136
    v_add_f32 v225, v225, v137
    v_add_f32 v226, v226, v138
    v_add_f32 v227, v227, v139
    v_add_f32 v228, v228, v140
    v_add_f32 v229, v229, v141
    v_add_f32 v230, v230, v142
    v_add_f32 v231, v231, v143
    v_exp_f32 v224, v224
    v_exp_f32 v225, v225
    v_exp_f32 v226, v226
    v_exp_f32 v227, v227
    v_exp_f32 v228, v228
    v_exp_f32 v229, v229
    v_exp_f32 v230, v230
    v_exp_f32 v231, v231
    v_add_f32 v224, 0.5, v224
    v_add_f32 v225, 0.5, v225
    v_add_f32 v226, 0.5, v226
    v_add_f32 v227, 0.5, v227
    v_add_f32 v228, 0.5, v228
    v_add_f32 v229, 0.5, v229
    v_add_f32 v230, 0.5, v230
    v_add_f32 v231, 0.5, v231
    v_rcp_f32 v224, v224
    v_rcp_f32 v225, v225
    v_rcp_f32 v226, v226
    v_rcp_f32 v227, v227
    v_rcp_f32 v228, v228
    v_rcp_f32 v229, v229
    v_rcp_f32 v230, v230
    v_rcp_f32 v231, v231
    v_sub_f32 v224, 1.0, v224
    v_sub_f32 v225, 1.0, v225
    v_sub_f32 v226, 1.0, v226
    v_sub_f32 v227, 1.0, v227
    v_sub_f32 v228, 1.0, v228
    v_sub_f32 v229, 1.0, v229
    v_sub_f32 v230, 1.0, v230
    v_sub_f32 v231, 1.0, v231
    v_cvt_pk_bf16_f32 v240, v224, v225
    v_cvt_pk_bf16_f32 v241, v226, v227
    v_cvt_pk_bf16_f32 v242, v228, v229
    v_cvt_pk_bf16_f32 v243, v230, v231
    ds_write_b128 v13, v[240:243] offset:8192
    ds_read_b128 v[224:227], v12 offset:2320
    ds_read_b128 v[228:231], v12 offset:2336
    s_waitcnt lgkmcnt(0)
    v_add_f32 v224, v224, v136
    v_add_f32 v225, v225, v137
    v_add_f32 v226, v226, v138
    v_add_f32 v227, v227, v139
    v_add_f32 v228, v228, v140
    v_add_f32 v229, v229, v141
    v_add_f32 v230, v230, v142
    v_add_f32 v231, v231, v143
    v_exp_f32 v224, v224
    v_exp_f32 v225, v225
    v_exp_f32 v226, v226
    v_exp_f32 v227, v227
    v_exp_f32 v228, v228
    v_exp_f32 v229, v229
    v_exp_f32 v230, v230
    v_exp_f32 v231, v231
    v_add_f32 v224, 0.5, v224
    v_add_f32 v225, 0.5, v225
    v_add_f32 v226, 0.5, v226
    v_add_f32 v227, 0.5, v227
    v_add_f32 v228, 0.5, v228
    v_add_f32 v229, 0.5, v229
    v_add_f32 v230, 0.5, v230
    v_add_f32 v231, 0.5, v231
    v_rcp_f32 v224, v224
    v_rcp_f32 v225, v225
    v_rcp_f32 v226, v226
    v_rcp_f32 v227, v227
    v_rcp_f32 v228, v228
    v_rcp_f32 v229, v229
    v_rcp_f32 v230, v230
    v_rcp_f32 v231, v231
    v_sub_f32 v224, 1.0, v224
    v_sub_f32 v225, 1.0, v225
    v_sub_f32 v226, 1.0, v226
    v_sub_f32 v227, 1.0, v227
    v_sub_f32 v228, 1.0, v228
    v_sub_f32 v229, 1.0, v229
    v_sub_f32 v230, 1.0, v230
    v_sub_f32 v231, 1.0, v231
    v_cvt_pk_bf16_f32 v240, v224, v225
    v_cvt_pk_bf16_f32 v241, v226, v227
    v_cvt_pk_bf16_f32 v242, v228, v229
    v_cvt_pk_bf16_f32 v243, v230, v231
    ds_write_b128 v13, v[240:243] offset:8320
    ds_read_b128 v[224:227], v12 offset:512
    ds_read_b128 v[228:231], v12 offset:528
    s_waitcnt lgkmcnt(0)
    v_add_f32 v224, v224, v144
    v_add_f32 v225, v225, v145
    v_add_f32 v226, v226, v146
    v_add_f32 v227, v227, v147
    v_add_f32 v228, v228, v148
    v_add_f32 v229, v229, v149
    v_add_f32 v230, v230, v150
    v_add_f32 v231, v231, v151
    v_exp_f32 v224, v224
    v_exp_f32 v225, v225
    v_exp_f32 v226, v226
    v_exp_f32 v227, v227
    v_exp_f32 v228, v228
    v_exp_f32 v229, v229
    v_exp_f32 v230, v230
    v_exp_f32 v231, v231
    v_add_f32 v224, 0.5, v224
    v_add_f32 v225, 0.5, v225
    v_add_f32 v226, 0.5, v226
    v_add_f32 v227, 0.5, v227
    v_add_f32 v228, 0.5, v228
    v_add_f32 v229, 0.5, v229
    v_add_f32 v230, 0.5, v230
    v_add_f32 v231, 0.5, v231
    v_rcp_f32 v224, v224
    v_rcp_f32 v225, v225
    v_rcp_f32 v226, v226
    v_rcp_f32 v227, v227
    v_rcp_f32 v228, v228
    v_rcp_f32 v229, v229
    v_rcp_f32 v230, v230
    v_rcp_f32 v231, v231
    v_sub_f32 v224, 1.0, v224
    v_sub_f32 v225, 1.0, v225
    v_sub_f32 v226, 1.0, v226
    v_sub_f32 v227, 1.0, v227
    v_sub_f32 v228, 1.0, v228
    v_sub_f32 v229, 1.0, v229
    v_sub_f32 v230, 1.0, v230
    v_sub_f32 v231, 1.0, v231
    v_cvt_pk_bf16_f32 v240, v224, v225
    v_cvt_pk_bf16_f32 v241, v226, v227
    v_cvt_pk_bf16_f32 v242, v228, v229
    v_cvt_pk_bf16_f32 v243, v230, v231
    ds_write_b128 v13, v[240:243] offset:16384
    ds_read_b128 v[224:227], v12 offset:2576
    ds_read_b128 v[228:231], v12 offset:2592
    s_waitcnt lgkmcnt(0)
    v_add_f32 v224, v224, v144
    v_add_f32 v225, v225, v145
    v_add_f32 v226, v226, v146
    v_add_f32 v227, v227, v147
    v_add_f32 v228, v228, v148
    v_add_f32 v229, v229, v149
    v_add_f32 v230, v230, v150
    v_add_f32 v231, v231, v151
    v_exp_f32 v224, v224
    v_exp_f32 v225, v225
    v_exp_f32 v226, v226
    v_exp_f32 v227, v227
    v_exp_f32 v228, v228
    v_exp_f32 v229, v229
    v_exp_f32 v230, v230
    v_exp_f32 v231, v231
    v_add_f32 v224, 0.5, v224
    v_add_f32 v225, 0.5, v225
    v_add_f32 v226, 0.5, v226
    v_add_f32 v227, 0.5, v227
    v_add_f32 v228, 0.5, v228
    v_add_f32 v229, 0.5, v229
    v_add_f32 v230, 0.5, v230
    v_add_f32 v231, 0.5, v231
    v_rcp_f32 v224, v224
    v_rcp_f32 v225, v225
    v_rcp_f32 v226, v226
    v_rcp_f32 v227, v227
    v_rcp_f32 v228, v228
    v_rcp_f32 v229, v229
    v_rcp_f32 v230, v230
    v_rcp_f32 v231, v231
    v_sub_f32 v224, 1.0, v224
    v_sub_f32 v225, 1.0, v225
    v_sub_f32 v226, 1.0, v226
    v_sub_f32 v227, 1.0, v227
    v_sub_f32 v228, 1.0, v228
    v_sub_f32 v229, 1.0, v229
    v_sub_f32 v230, 1.0, v230
    v_sub_f32 v231, 1.0, v231
    v_cvt_pk_bf16_f32 v240, v224, v225
    v_cvt_pk_bf16_f32 v241, v226, v227
    v_cvt_pk_bf16_f32 v242, v228, v229
    v_cvt_pk_bf16_f32 v243, v230, v231
    ds_write_b128 v13, v[240:243] offset:16512
    ds_read_b128 v[224:227], v12 offset:768
    ds_read_b128 v[228:231], v12 offset:784
    s_waitcnt lgkmcnt(0)
    v_add_f32 v224, v224, v152
    v_add_f32 v225, v225, v153
    v_add_f32 v226, v226, v154
    v_add_f32 v227, v227, v155
    v_add_f32 v228, v228, v156
    v_add_f32 v229, v229, v157
    v_add_f32 v230, v230, v158
    v_add_f32 v231, v231, v159
    v_exp_f32 v224, v224
    v_exp_f32 v225, v225
    v_exp_f32 v226, v226
    v_exp_f32 v227, v227
    v_exp_f32 v228, v228
    v_exp_f32 v229, v229
    v_exp_f32 v230, v230
    v_exp_f32 v231, v231
    v_add_f32 v224, 0.5, v224
    v_add_f32 v225, 0.5, v225
    v_add_f32 v226, 0.5, v226
    v_add_f32 v227, 0.5, v227
    v_add_f32 v228, 0.5, v228
    v_add_f32 v229, 0.5, v229
    v_add_f32 v230, 0.5, v230
    v_add_f32 v231, 0.5, v231
    v_rcp_f32 v224, v224
    v_rcp_f32 v225, v225
    v_rcp_f32 v226, v226
    v_rcp_f32 v227, v227
    v_rcp_f32 v228, v228
    v_rcp_f32 v229, v229
    v_rcp_f32 v230, v230
    v_rcp_f32 v231, v231
    v_sub_f32 v224, 1.0, v224
    v_sub_f32 v225, 1.0, v225
    v_sub_f32 v226, 1.0, v226
    v_sub_f32 v227, 1.0, v227
    v_sub_f32 v228, 1.0, v228
    v_sub_f32 v229, 1.0, v229
    v_sub_f32 v230, 1.0, v230
    v_sub_f32 v231, 1.0, v231
    v_cvt_pk_bf16_f32 v240, v224, v225
    v_cvt_pk_bf16_f32 v241, v226, v227
    v_cvt_pk_bf16_f32 v242, v228, v229
    v_cvt_pk_bf16_f32 v243, v230, v231
    ds_write_b128 v13, v[240:243] offset:24576
    ds_read_b128 v[224:227], v12 offset:2832
    ds_read_b128 v[228:231], v12 offset:2848
    s_waitcnt lgkmcnt(0)
    v_add_f32 v224, v224, v152
    v_add_f32 v225, v225, v153
    v_add_f32 v226, v226, v154
    v_add_f32 v227, v227, v155
    v_add_f32 v228, v228, v156
    v_add_f32 v229, v229, v157
    v_add_f32 v230, v230, v158
    v_add_f32 v231, v231, v159
    v_exp_f32 v224, v224
    v_exp_f32 v225, v225
    v_exp_f32 v226, v226
    v_exp_f32 v227, v227
    v_exp_f32 v228, v228
    v_exp_f32 v229, v229
    v_exp_f32 v230, v230
    v_exp_f32 v231, v231
    v_add_f32 v224, 0.5, v224
    v_add_f32 v225, 0.5, v225
    v_add_f32 v226, 0.5, v226
    v_add_f32 v227, 0.5, v227
    v_add_f32 v228, 0.5, v228
    v_add_f32 v229, 0.5, v229
    v_add_f32 v230, 0.5, v230
    v_add_f32 v231, 0.5, v231
    v_rcp_f32 v224, v224
    v_rcp_f32 v225, v225
    v_rcp_f32 v226, v226
    v_rcp_f32 v227, v227
    v_rcp_f32 v228, v228
    v_rcp_f32 v229, v229
    v_rcp_f32 v230, v230
    v_rcp_f32 v231, v231
    v_sub_f32 v224, 1.0, v224
    v_sub_f32 v225, 1.0, v225
    v_sub_f32 v226, 1.0, v226
    v_sub_f32 v227, 1.0, v227
    v_sub_f32 v228, 1.0, v228
    v_sub_f32 v229, 1.0, v229
    v_sub_f32 v230, 1.0, v230
    v_sub_f32 v231, 1.0, v231
    v_cvt_pk_bf16_f32 v240, v224, v225
    v_cvt_pk_bf16_f32 v241, v226, v227
    v_cvt_pk_bf16_f32 v242, v228, v229
    v_cvt_pk_bf16_f32 v243, v230, v231
    ds_write_b128 v13, v[240:243] offset:24704
    ds_read_b128 v[224:227], v12 offset:1024
    ds_read_b128 v[228:231], v12 offset:1040
    s_waitcnt lgkmcnt(0)
    v_add_f32 v224, v224, v160
    v_add_f32 v225, v225, v161
    v_add_f32 v226, v226, v162
    v_add_f32 v227, v227, v163
    v_add_f32 v228, v228, v164
    v_add_f32 v229, v229, v165
    v_add_f32 v230, v230, v166
    v_add_f32 v231, v231, v167
    v_exp_f32 v224, v224
    v_exp_f32 v225, v225
    v_exp_f32 v226, v226
    v_exp_f32 v227, v227
    v_exp_f32 v228, v228
    v_exp_f32 v229, v229
    v_exp_f32 v230, v230
    v_exp_f32 v231, v231
    v_add_f32 v224, 0.5, v224
    v_add_f32 v225, 0.5, v225
    v_add_f32 v226, 0.5, v226
    v_add_f32 v227, 0.5, v227
    v_add_f32 v228, 0.5, v228
    v_add_f32 v229, 0.5, v229
    v_add_f32 v230, 0.5, v230
    v_add_f32 v231, 0.5, v231
    v_rcp_f32 v224, v224
    v_rcp_f32 v225, v225
    v_rcp_f32 v226, v226
    v_rcp_f32 v227, v227
    v_rcp_f32 v228, v228
    v_rcp_f32 v229, v229
    v_rcp_f32 v230, v230
    v_rcp_f32 v231, v231
    v_sub_f32 v224, 1.0, v224
    v_sub_f32 v225, 1.0, v225
    v_sub_f32 v226, 1.0, v226
    v_sub_f32 v227, 1.0, v227
    v_sub_f32 v228, 1.0, v228
    v_sub_f32 v229, 1.0, v229
    v_sub_f32 v230, 1.0, v230
    v_sub_f32 v231, 1.0, v231
    v_cvt_pk_bf16_f32 v240, v224, v225
    v_cvt_pk_bf16_f32 v241, v226, v227
    v_cvt_pk_bf16_f32 v242, v228, v229
    v_cvt_pk_bf16_f32 v243, v230, v231
    ds_write_b128 v13, v[240:243] offset:32768
    ds_read_b128 v[224:227], v12 offset:3088
    ds_read_b128 v[228:231], v12 offset:3104
    s_waitcnt lgkmcnt(0)
    v_add_f32 v224, v224, v160
    v_add_f32 v225, v225, v161
    v_add_f32 v226, v226, v162
    v_add_f32 v227, v227, v163
    v_add_f32 v228, v228, v164
    v_add_f32 v229, v229, v165
    v_add_f32 v230, v230, v166
    v_add_f32 v231, v231, v167
    v_exp_f32 v224, v224
    v_exp_f32 v225, v225
    v_exp_f32 v226, v226
    v_exp_f32 v227, v227
    v_exp_f32 v228, v228
    v_exp_f32 v229, v229
    v_exp_f32 v230, v230
    v_exp_f32 v231, v231
    v_add_f32 v224, 0.5, v224
    v_add_f32 v225, 0.5, v225
    v_add_f32 v226, 0.5, v226
    v_add_f32 v227, 0.5, v227
    v_add_f32 v228, 0.5, v228
    v_add_f32 v229, 0.5, v229
    v_add_f32 v230, 0.5, v230
    v_add_f32 v231, 0.5, v231
    v_rcp_f32 v224, v224
    v_rcp_f32 v225, v225
    v_rcp_f32 v226, v226
    v_rcp_f32 v227, v227
    v_rcp_f32 v228, v228
    v_rcp_f32 v229, v229
    v_rcp_f32 v230, v230
    v_rcp_f32 v231, v231
    v_sub_f32 v224, 1.0, v224
    v_sub_f32 v225, 1.0, v225
    v_sub_f32 v226, 1.0, v226
    v_sub_f32 v227, 1.0, v227
    v_sub_f32 v228, 1.0, v228
    v_sub_f32 v229, 1.0, v229
    v_sub_f32 v230, 1.0, v230
    v_sub_f32 v231, 1.0, v231
    v_cvt_pk_bf16_f32 v240, v224, v225
    v_cvt_pk_bf16_f32 v241, v226, v227
    v_cvt_pk_bf16_f32 v242, v228, v229
    v_cvt_pk_bf16_f32 v243, v230, v231
    ds_write_b128 v13, v[240:243] offset:32896
    ds_read_b128 v[224:227], v12 offset:1280
    ds_read_b128 v[228:231], v12 offset:1296
    s_waitcnt lgkmcnt(0)
    v_add_f32 v224, v224, v168
    v_add_f32 v225, v225, v169
    v_add_f32 v226, v226, v170
    v_add_f32 v227, v227, v171
    v_add_f32 v228, v228, v172
    v_add_f32 v229, v229, v173
    v_add_f32 v230, v230, v174
    v_add_f32 v231, v231, v175
    v_exp_f32 v224, v224
    v_exp_f32 v225, v225
    v_exp_f32 v226, v226
    v_exp_f32 v227, v227
    v_exp_f32 v228, v228
    v_exp_f32 v229, v229
    v_exp_f32 v230, v230
    v_exp_f32 v231, v231
    v_add_f32 v224, 0.5, v224
    v_add_f32 v225, 0.5, v225
    v_add_f32 v226, 0.5, v226
    v_add_f32 v227, 0.5, v227
    v_add_f32 v228, 0.5, v228
    v_add_f32 v229, 0.5, v229
    v_add_f32 v230, 0.5, v230
    v_add_f32 v231, 0.5, v231
    v_rcp_f32 v224, v224
    v_rcp_f32 v225, v225
    v_rcp_f32 v226, v226
    v_rcp_f32 v227, v227
    v_rcp_f32 v228, v228
    v_rcp_f32 v229, v229
    v_rcp_f32 v230, v230
    v_rcp_f32 v231, v231
    v_sub_f32 v224, 1.0, v224
    v_sub_f32 v225, 1.0, v225
    v_sub_f32 v226, 1.0, v226
    v_sub_f32 v227, 1.0, v227
    v_sub_f32 v228, 1.0, v228
    v_sub_f32 v229, 1.0, v229
    v_sub_f32 v230, 1.0, v230
    v_sub_f32 v231, 1.0, v231
    v_cvt_pk_bf16_f32 v240, v224, v225
    v_cvt_pk_bf16_f32 v241, v226, v227
    v_cvt_pk_bf16_f32 v242, v228, v229
    v_cvt_pk_bf16_f32 v243, v230, v231
    ds_write_b128 v13, v[240:243] offset:40960
    ds_read_b128 v[224:227], v12 offset:3344
    ds_read_b128 v[228:231], v12 offset:3360
    s_waitcnt lgkmcnt(0)
    v_add_f32 v224, v224, v168
    v_add_f32 v225, v225, v169
    v_add_f32 v226, v226, v170
    v_add_f32 v227, v227, v171
    v_add_f32 v228, v228, v172
    v_add_f32 v229, v229, v173
    v_add_f32 v230, v230, v174
    v_add_f32 v231, v231, v175
    v_exp_f32 v224, v224
    v_exp_f32 v225, v225
    v_exp_f32 v226, v226
    v_exp_f32 v227, v227
    v_exp_f32 v228, v228
    v_exp_f32 v229, v229
    v_exp_f32 v230, v230
    v_exp_f32 v231, v231
    v_add_f32 v224, 0.5, v224
    v_add_f32 v225, 0.5, v225
    v_add_f32 v226, 0.5, v226
    v_add_f32 v227, 0.5, v227
    v_add_f32 v228, 0.5, v228
    v_add_f32 v229, 0.5, v229
    v_add_f32 v230, 0.5, v230
    v_add_f32 v231, 0.5, v231
    v_rcp_f32 v224, v224
    v_rcp_f32 v225, v225
    v_rcp_f32 v226, v226
    v_rcp_f32 v227, v227
    v_rcp_f32 v228, v228
    v_rcp_f32 v229, v229
    v_rcp_f32 v230, v230
    v_rcp_f32 v231, v231
    v_sub_f32 v224, 1.0, v224
    v_sub_f32 v225, 1.0, v225
    v_sub_f32 v226, 1.0, v226
    v_sub_f32 v227, 1.0, v227
    v_sub_f32 v228, 1.0, v228
    v_sub_f32 v229, 1.0, v229
    v_sub_f32 v230, 1.0, v230
    v_sub_f32 v231, 1.0, v231
    v_cvt_pk_bf16_f32 v240, v224, v225
    v_cvt_pk_bf16_f32 v241, v226, v227
    v_cvt_pk_bf16_f32 v242, v228, v229
    v_cvt_pk_bf16_f32 v243, v230, v231
    ds_write_b128 v13, v[240:243] offset:41088
    ds_read_b128 v[224:227], v12 offset:1536
    ds_read_b128 v[228:231], v12 offset:1552
    s_waitcnt lgkmcnt(0)
    v_add_f32 v224, v224, v176
    v_add_f32 v225, v225, v177
    v_add_f32 v226, v226, v178
    v_add_f32 v227, v227, v179
    v_add_f32 v228, v228, v180
    v_add_f32 v229, v229, v181
    v_add_f32 v230, v230, v182
    v_add_f32 v231, v231, v183
    v_exp_f32 v224, v224
    v_exp_f32 v225, v225
    v_exp_f32 v226, v226
    v_exp_f32 v227, v227
    v_exp_f32 v228, v228
    v_exp_f32 v229, v229
    v_exp_f32 v230, v230
    v_exp_f32 v231, v231
    v_add_f32 v224, 0.5, v224
    v_add_f32 v225, 0.5, v225
    v_add_f32 v226, 0.5, v226
    v_add_f32 v227, 0.5, v227
    v_add_f32 v228, 0.5, v228
    v_add_f32 v229, 0.5, v229
    v_add_f32 v230, 0.5, v230
    v_add_f32 v231, 0.5, v231
    v_rcp_f32 v224, v224
    v_rcp_f32 v225, v225
    v_rcp_f32 v226, v226
    v_rcp_f32 v227, v227
    v_rcp_f32 v228, v228
    v_rcp_f32 v229, v229
    v_rcp_f32 v230, v230
    v_rcp_f32 v231, v231
    v_sub_f32 v224, 1.0, v224
    v_sub_f32 v225, 1.0, v225
    v_sub_f32 v226, 1.0, v226
    v_sub_f32 v227, 1.0, v227
    v_sub_f32 v228, 1.0, v228
    v_sub_f32 v229, 1.0, v229
    v_sub_f32 v230, 1.0, v230
    v_sub_f32 v231, 1.0, v231
    v_cvt_pk_bf16_f32 v240, v224, v225
    v_cvt_pk_bf16_f32 v241, v226, v227
    v_cvt_pk_bf16_f32 v242, v228, v229
    v_cvt_pk_bf16_f32 v243, v230, v231
    ds_write_b128 v13, v[240:243] offset:49152
    ds_read_b128 v[224:227], v12 offset:3600
    ds_read_b128 v[228:231], v12 offset:3616
    s_waitcnt lgkmcnt(0)
    v_add_f32 v224, v224, v176
    v_add_f32 v225, v225, v177
    v_add_f32 v226, v226, v178
    v_add_f32 v227, v227, v179
    v_add_f32 v228, v228, v180
    v_add_f32 v229, v229, v181
    v_add_f32 v230, v230, v182
    v_add_f32 v231, v231, v183
    v_exp_f32 v224, v224
    v_exp_f32 v225, v225
    v_exp_f32 v226, v226
    v_exp_f32 v227, v227
    v_exp_f32 v228, v228
    v_exp_f32 v229, v229
    v_exp_f32 v230, v230
    v_exp_f32 v231, v231
    v_add_f32 v224, 0.5, v224
    v_add_f32 v225, 0.5, v225
    v_add_f32 v226, 0.5, v226
    v_add_f32 v227, 0.5, v227
    v_add_f32 v228, 0.5, v228
    v_add_f32 v229, 0.5, v229
    v_add_f32 v230, 0.5, v230
    v_add_f32 v231, 0.5, v231
    v_rcp_f32 v224, v224
    v_rcp_f32 v225, v225
    v_rcp_f32 v226, v226
    v_rcp_f32 v227, v227
    v_rcp_f32 v228, v228
    v_rcp_f32 v229, v229
    v_rcp_f32 v230, v230
    v_rcp_f32 v231, v231
    v_sub_f32 v224, 1.0, v224
    v_sub_f32 v225, 1.0, v225
    v_sub_f32 v226, 1.0, v226
    v_sub_f32 v227, 1.0, v227
    v_sub_f32 v228, 1.0, v228
    v_sub_f32 v229, 1.0, v229
    v_sub_f32 v230, 1.0, v230
    v_sub_f32 v231, 1.0, v231
    v_cvt_pk_bf16_f32 v240, v224, v225
    v_cvt_pk_bf16_f32 v241, v226, v227
    v_cvt_pk_bf16_f32 v242, v228, v229
    v_cvt_pk_bf16_f32 v243, v230, v231
    ds_write_b128 v13, v[240:243] offset:49280
    ds_read_b128 v[224:227], v12 offset:1792
    ds_read_b128 v[228:231], v12 offset:1808
    s_waitcnt lgkmcnt(0)
    v_add_f32 v224, v224, v184
    v_add_f32 v225, v225, v185
    v_add_f32 v226, v226, v186
    v_add_f32 v227, v227, v187
    v_add_f32 v228, v228, v188
    v_add_f32 v229, v229, v189
    v_add_f32 v230, v230, v190
    v_add_f32 v231, v231, v191
    v_exp_f32 v224, v224
    v_exp_f32 v225, v225
    v_exp_f32 v226, v226
    v_exp_f32 v227, v227
    v_exp_f32 v228, v228
    v_exp_f32 v229, v229
    v_exp_f32 v230, v230
    v_exp_f32 v231, v231
    v_add_f32 v224, 0.5, v224
    v_add_f32 v225, 0.5, v225
    v_add_f32 v226, 0.5, v226
    v_add_f32 v227, 0.5, v227
    v_add_f32 v228, 0.5, v228
    v_add_f32 v229, 0.5, v229
    v_add_f32 v230, 0.5, v230
    v_add_f32 v231, 0.5, v231
    v_rcp_f32 v224, v224
    v_rcp_f32 v225, v225
    v_rcp_f32 v226, v226
    v_rcp_f32 v227, v227
    v_rcp_f32 v228, v228
    v_rcp_f32 v229, v229
    v_rcp_f32 v230, v230
    v_rcp_f32 v231, v231
    v_sub_f32 v224, 1.0, v224
    v_sub_f32 v225, 1.0, v225
    v_sub_f32 v226, 1.0, v226
    v_sub_f32 v227, 1.0, v227
    v_sub_f32 v228, 1.0, v228
    v_sub_f32 v229, 1.0, v229
    v_sub_f32 v230, 1.0, v230
    v_sub_f32 v231, 1.0, v231
    v_cvt_pk_bf16_f32 v240, v224, v225
    v_cvt_pk_bf16_f32 v241, v226, v227
    v_cvt_pk_bf16_f32 v242, v228, v229
    v_cvt_pk_bf16_f32 v243, v230, v231
    ds_write_b128 v13, v[240:243] offset:57344
    ds_read_b128 v[224:227], v12 offset:3856
    ds_read_b128 v[228:231], v12 offset:3872
    s_waitcnt lgkmcnt(0)
    v_add_f32 v224, v224, v184
    v_add_f32 v225, v225, v185
    v_add_f32 v226, v226, v186
    v_add_f32 v227, v227, v187
    v_add_f32 v228, v228, v188
    v_add_f32 v229, v229, v189
    v_add_f32 v230, v230, v190
    v_add_f32 v231, v231, v191
    v_exp_f32 v224, v224
    v_exp_f32 v225, v225
    v_exp_f32 v226, v226
    v_exp_f32 v227, v227
    v_exp_f32 v228, v228
    v_exp_f32 v229, v229
    v_exp_f32 v230, v230
    v_exp_f32 v231, v231
    v_add_f32 v224, 0.5, v224
    v_add_f32 v225, 0.5, v225
    v_add_f32 v226, 0.5, v226
    v_add_f32 v227, 0.5, v227
    v_add_f32 v228, 0.5, v228
    v_add_f32 v229, 0.5, v229
    v_add_f32 v230, 0.5, v230
    v_add_f32 v231, 0.5, v231
    v_rcp_f32 v224, v224
    v_rcp_f32 v225, v225
    v_rcp_f32 v226, v226
    v_rcp_f32 v227, v227
    v_rcp_f32 v228, v228
    v_rcp_f32 v229, v229
    v_rcp_f32 v230, v230
    v_rcp_f32 v231, v231
    v_sub_f32 v224, 1.0, v224
    v_sub_f32 v225, 1.0, v225
    v_sub_f32 v226, 1.0, v226
    v_sub_f32 v227, 1.0, v227
    v_sub_f32 v228, 1.0, v228
    v_sub_f32 v229, 1.0, v229
    v_sub_f32 v230, 1.0, v230
    v_sub_f32 v231, 1.0, v231
    v_cvt_pk_bf16_f32 v240, v224, v225
    v_cvt_pk_bf16_f32 v241, v226, v227
    v_cvt_pk_bf16_f32 v242, v228, v229
    v_cvt_pk_bf16_f32 v243, v230, v231
    ds_write_b128 v13, v[240:243] offset:57472
    s_waitcnt lgkmcnt(0)
    s_barrier
    ds_read_b128 v[192:195], v28 offset:0
    ds_read_b128 v[196:199], v28 offset:512
    ds_read_b128 v[200:203], v28 offset:2048
    ds_read_b128 v[204:207], v28 offset:2560
    s_waitcnt lgkmcnt(0)
    v_add_u32 v13, 163840, v13
    s_branch L_SLOWRET
.section .rodata,"a"
.p2align 6
.amdhsa_kernel standalone__seq2seq_rnn_t_joint__speech_kernel
  .amdhsa_next_free_vgpr 512
  .amdhsa_next_free_sgpr 102
  .amdhsa_accum_offset 256
  .amdhsa_group_segment_fixed_size 0
  .amdhsa_kernarg_size 80
  .amdhsa_user_sgpr_count 2
  .amdhsa_user_sgpr_kernarg_segment_ptr 1
  .amdhsa_system_sgpr_workgroup_id_x 1
.end_amdhsa_kernel
```
